```python
import torch

def _softmax(x, axis=-1):
    return torch.softmax(x, dim=axis)

def _gelu(x):
    return torch.nn.functional.gelu(x, approximate='tanh')

def _silu(x):
    return torch.nn.functional.silu(x)

def _sigmoid(x):
    return torch.sigmoid(x)

def _layernorm(x, axis=-1, eps=1e-05):
    m = x.mean(dim=axis, keepdim=True)
    v = x.var(dim=axis, keepdim=True, unbiased=False)
    return (x - m) / torch.sqrt(v + eps)

def _scatter_add(tgt, idx, src, axis=0):
    return tgt.clone().index_add_(axis, idx, src)

def _segment_sum(src, seg, n):
    out = torch.zeros((n,) + src.shape[1:], dtype=src.dtype)
    return out.index_add_(0, seg, src)

def _pad(x, pw):
    flat = tuple((v for pair in reversed(pw) for v in pair))
    return torch.nn.functional.pad(x, flat)
kernel_name = 'adaLN_cond__spectral_gfnet__moe_arch_mod__prompt'

def setup_inputs():

    _w = lambda a: (lambda t: t.to(torch.bfloat16) if t.is_floating_point() else t)(torch.as_tensor(a))

    def _A_setup():
        B, S, D = (1, 2048, 640)
        Df = D // 2 + 1
        return {'x': _w((lambda *s: torch.randn(*s, dtype=torch.bfloat16) * 0.05)(B, S, D)), 'w_r': _w((lambda *s: torch.randn(*s, dtype=torch.bfloat16) * 3.2)(S, Df) * 0.02), 'w_i': _w((lambda *s: torch.randn(*s, dtype=torch.bfloat16) * 3.2)(S, Df) * 0.02)}
    _A_in = _A_setup()

    def _B_setup():
        B, S, D, F, C = (1, 2048, 640, 1728, 8)
        return {'x': _w((lambda *s: torch.randn(*s, dtype=torch.bfloat16) * 0.05)(B, S, D)), 'w_r': _w((lambda *s: torch.randn(*s, dtype=torch.bfloat16) * 0.2)(D)), 'w_gate': _w((lambda *s: torch.randn(*s, dtype=torch.bfloat16) * 0.2)(D, F)), 'w_up': _w((lambda *s: torch.randn(*s, dtype=torch.bfloat16) * 0.2)(D, F)), 'w_down': _w((lambda *s: torch.randn(*s, dtype=torch.bfloat16) * 0.2)(F, D))}
    _B_in = _B_setup()
    return {'A_x': _A_in['x'], 'A_w_r': _A_in['w_r'], 'A_w_i': _A_in['w_i'], 'B_x': _B_in['x'], 'B_w_r': _B_in['w_r'], 'B_w_gate': _B_in['w_gate'], 'B_w_up': _B_in['w_up'], 'B_w_down': _B_in['w_down'], 'c': _w((lambda *s: torch.randn(*s, dtype=torch.bfloat16) * 0.1)(1, 640) * 8.0), 'w_mod': _w((lambda *s: torch.randn(*s, dtype=torch.bfloat16) * 0.1)(640, 6 * 640) * 640 ** (-0.5) * 8.0)}

def reference(A_x, A_w_r, A_w_i, B_x, B_w_r, B_w_gate, B_w_up, B_w_down, c, w_mod):

    def _A_ref(x, w_r, w_i):
        B, S, D = x.shape
        X = (lambda x, axes=(-2, -1): torch.fft.rfft2(x.float(), dim=axes))(x, axes=(-2, -1))
        W = w_r + 1j * w_i
        X = X * W
        y = (lambda x, s, axes=(-2, -1): torch.fft.irfft2(x, s=s, dim=axes).to(torch.bfloat16))(X, (S, D), axes=(-2, -1))
        return y

    def _B_ref(x, w_r, w_gate, w_up, w_down):
        B, S, D = x.shape
        C = 8
        r = x @ w_r
        idx = torch.argsort(-r, axis=-1)[:, :C]
        idx_e = (lambda x, n, axis: torch.repeat_interleave(x, n, dim=axis))(idx.reshape(B, C, 1), D, axis=2)
        x_sel = (lambda x, i, axis: torch.take_along_dim(x, i, dim=axis))(x, idx_e, axis=1)
        g = _silu(x_sel @ w_gate)
        u = x_sel @ w_up
        y = g * u @ w_down
        r_sel = _sigmoid((lambda x, i, axis: torch.take_along_dim(x, i, dim=axis))(r, idx, axis=1))
        y = y * r_sel.reshape(B, C, 1)
        b_off = (torch.arange(B) * S).reshape(B, 1)
        flat_idx = (idx + b_off).reshape(B * C)
        zero = (x * 0.0).reshape(B * S, D)
        upd = _scatter_add(zero, flat_idx, y.reshape(B * C, D), axis=0)
        return x + upd.reshape(B, S, D)
    x = A_x
    mod = (_silu(c) @ w_mod).reshape(c.shape[0], 6, 1, -1)
    sa, ca, ga, sb, cb, gb = (mod[:, 0].clone(), mod[:, 1].clone(), mod[:, 2].clone(), mod[:, 3].clone(), mod[:, 4].clone(), mod[:, 5].clone())
    h = _layernorm(x, axis=-1) * (1 + ca) + sa
    x = x + ga * _A_ref(h, A_w_r, A_w_i)
    h = _layernorm(x, axis=-1) * (1 + cb) + sb
    x = x + gb * _B_ref(h, B_w_r, B_w_gate, B_w_up, B_w_down)
    return x
```

```asm
; @launch kernel=km_kernel grid=(480,1,1) block=(512,1,1) lds=75008
.amdgcn_target "amdgcn-amd-amdhsa--gfx950"
.text
.globl km_kernel
.p2align 8
.type km_kernel,@function
km_kernel:
    s_load_dwordx16 s[16:31], s[0:1], 0
    s_load_dwordx8 s[32:39], s[0:1], 64
    s_load_dwordx2 s[40:41], s[0:1], 96
    s_cmp_ge_u32 s2, 480
    s_cbranch_scc1 KM_EXIT
    v_and_b32 v1, 63, v0
    v_lshrrev_b32 v2, 6, v0
    s_nop 0
    v_readfirstlane_b32 s3, v2
    s_cmp_ge_u32 s2, 256
    s_cbranch_scc1 HELPER
    s_sub_u32 s4, s2, 200
    s_cmp_ge_u32 s4, 8
    s_cbranch_scc1 KM_NPF
    s_getpc_b64 s[56:57]
Lpcc:
    s_sub_u32 s56, s56, Lpcc-km_kernel
    s_subb_u32 s57, s57, 0
    s_mov_b32 s58, tbl+20480-km_kernel
    s_mov_b32 s59, 0x20000
    v_lshlrev_b32 v2, 7, v0
    buffer_load_dword v126, v2, s[56:59], 0 offen
    buffer_load_dword v126, v2, s[56:59], 0 offen offset:64
KM_NPF:
    s_and_b32 s4, s2, 7
    s_lshl_b32 s4, s4, 5
    s_lshr_b32 s5, s2, 3
    s_add_u32 s4, s4, s5
    s_lshl_b32 s5, s3, 8
    s_add_u32 s5, s5, s4
    s_mul_i32 s6, s5, 1280
    v_lshlrev_b32 v3, 2, v1
    v_lshlrev_b32 v5, 4, v1
    v_mov_b32 v116, -1
    v_mov_b32 v117, -1
    v_mov_b32 v118, -1
    v_mov_b32 v119, -1
    s_sub_u32 s43, s2, 216
    s_mul_i32 s7, s43, 3277
    s_lshr_b32 s7, s7, 16
    s_mul_i32 s8, s7, 20
    s_sub_u32 s8, s43, s8
    v_lshrrev_b32 v101, 3, v0
    v_and_b32 v2, 7, v0
    s_movk_i32 s9, 7680
    v_mul_u32_u24 v100, s9, v101
    v_lshl_add_u32 v100, v2, 4, v100
    v_lshlrev_b32 v101, 1, v101
    s_mul_i32 s9, s7, 2457600
    s_lshl_b32 s8, s8, 7
    s_add_u32 s8, s8, s9
    s_mul_i32 s7, s7, 640
    s_mul_i32 s84, s2, 1639
    s_lshr_b32 s84, s84, 16
    s_mul_i32 s86, s84, 40
    s_sub_u32 s85, s2, s86
    s_lshl_b32 s86, s85, 7
    s_mul_i32 s87, s84, 983040
    s_add_u32 s86, s86, s87
    s_lshl_b32 s87, s84, 8
    s_waitcnt lgkmcnt(0)
    s_mov_b32 s44, s40
    s_mov_b32 s45, s41
    s_mov_b32 s46, 0x4000000
    s_mov_b32 s47, 0x20000
    s_load_dword s1, s[40:41], 0x30000
    s_mov_b32 s52, s34
    s_mov_b32 s53, s35
    s_mov_b32 s54, 0x4b0000
    s_mov_b32 s55, 0x20000
    s_mov_b32 s64, s32
    s_mov_b32 s65, s33
    s_mov_b32 s66, 0x500
    s_mov_b32 s67, 0x20000
    s_cmp_ge_u32 s43, 40
    s_cbranch_scc1 F_NP
    buffer_load_ushort v28, v101, s[64:67], s7 offen offset:0
    buffer_load_ushort v29, v101, s[64:67], s7 offen offset:128
    buffer_load_ushort v30, v101, s[64:67], s7 offen offset:256
    buffer_load_ushort v31, v101, s[64:67], s7 offen offset:384
    buffer_load_ushort v32, v101, s[64:67], s7 offen offset:512
    buffer_load_dwordx4 v[8:11], v100, s[52:55], s8 offen nt
    s_add_u32 s8, s8, 491520
    buffer_load_dwordx4 v[12:15], v100, s[52:55], s8 offen nt
    s_add_u32 s8, s8, 491520
    buffer_load_dwordx4 v[16:19], v100, s[52:55], s8 offen nt
    s_add_u32 s8, s8, 491520
    buffer_load_dwordx4 v[20:23], v100, s[52:55], s8 offen nt
    s_add_u32 s8, s8, 491520
    buffer_load_dwordx4 v[24:27], v100, s[52:55], s8 offen nt
F_NP:
    s_mov_b32 s48, s16
    s_mov_b32 s49, s17
    s_mov_b32 s50, 0x280000
    s_mov_b32 s51, 0x20000
    buffer_load_dwordx4 v[120:123], v5, s[48:51], s6 offen offset:0 nt
    buffer_load_dword v124, v3, s[48:51], s6 offen offset:1024 nt
    v_and_b32 v6, 15, v1
    v_lshrrev_b32 v7, 4, v1
    s_getpc_b64 s[56:57]
Lpc1:
    s_add_u32 s56, s56, tbl-Lpc1
    s_addc_u32 s57, s57, 0
    s_mov_b32 s58, 0x5000
    s_mov_b32 s59, 0x20000
    s_lshl_b32 s7, s3, 10
    s_add_u32 s8, s7, 36096
    s_mov_b32 m0, s8
    s_nop 0
    buffer_load_dwordx4 v5, s[56:59], s7 offen lds
    s_add_u32 s8, s8, 8192
    s_add_u32 s7, s7, 8192
    s_mov_b32 m0, s8
    s_nop 0
    buffer_load_dwordx4 v5, s[56:59], s7 offen lds
    s_add_u32 s8, s8, 8192
    s_add_u32 s7, s7, 8192
    s_cmp_ge_u32 s3, 4
    s_cselect_b32 s8, 66816, s8
    s_mov_b32 m0, s8
    s_nop 0
    buffer_load_dwordx4 v5, s[56:59], s7 offen lds
    s_lshl_b32 s7, s4, 3
    s_add_u32 s7, s7, s3
    s_lshl_b32 s8, s7, 7
    s_add_u32 s7, s8, 557056
    s_cmp_ge_u32 s8, 27648
    s_cselect_b32 s7, 0x4000000, s7
    s_mov_b64 exec, 0xff
    buffer_store_dwordx4 v[116:119], v5, s[44:47], s7 offen sc1
    s_mov_b64 exec, -1
    v_lshlrev_b32 v102, 3, v7
    v_lshl_add_u32 v102, v2, 5, v102
    s_lshl_b32 s7, s3, 8
    v_add_u32 v102, s7, v102
    v_mov_b32 v2, 0
    ds_write_b32 v2, v2 offset:36032
    ds_write_b32 v2, v2 offset:36036
    s_cmp_ge_u32 s3, 5
    s_cbranch_scc1 K1_L2
    v_and_b32 v96, 3, v6
    v_lshl_add_u32 v96, v7, 3, v96
    v_cvt_f32_u32 v96, v96
    v_lshrrev_b32 v97, 2, v6
    v_mul_u32_u24 v97, s4, v97
    v_cvt_f32_u32 v97, v97
    v_mul_f32 v97, 0x3a000000, v97
    s_lshl_b32 s7, s3, 1
    v_cvt_f32_u32 v98, s7
    v_add_f32 v99, 1.0, v98
    v_mul_f32 v98, 0x3acccccd, v98
    v_mul_f32 v99, 0x3acccccd, v99
    v_add_f32 v64, 4.0, v96
    v_add_f32 v65, 0x42000000, v96
    v_add_f32 v66, 0x42100000, v96
    s_mov_b32 s8, 0x3ea1e89b
    s_mov_b32 s9, 0xbea1e89b
    v_fma_f32 v104, v96, v98, v97
    v_fma_f32 v105, v96, v99, v97
    v_fma_f32 v106, v64, v98, v97
    v_fma_f32 v107, v64, v99, v97
    v_fma_f32 v108, v65, v98, v97
    v_fma_f32 v109, v65, v99, v97
    v_fma_f32 v110, v66, v98, v97
    v_fma_f32 v111, v66, v99, v97
    v_cos_f32 v72, v104
    v_sin_f32 v73, v104
    v_cos_f32 v74, v105
    v_sin_f32 v75, v105
    v_cos_f32 v76, v106
    v_sin_f32 v77, v106
    v_cos_f32 v78, v107
    v_sin_f32 v79, v107
    v_cos_f32 v80, v108
    v_sin_f32 v81, v108
    v_cos_f32 v82, v109
    v_sin_f32 v83, v109
    v_cos_f32 v84, v110
    v_sin_f32 v85, v110
    v_cos_f32 v86, v111
    v_sin_f32 v87, v111
    v_pk_mul_f32 v[72:73], v[72:73], s[8:9]
    v_pk_mul_f32 v[74:75], v[74:75], s[8:9]
    v_pk_mul_f32 v[76:77], v[76:77], s[8:9]
    v_pk_mul_f32 v[78:79], v[78:79], s[8:9]
    v_pk_mul_f32 v[80:81], v[80:81], s[8:9]
    v_pk_mul_f32 v[82:83], v[82:83], s[8:9]
    v_pk_mul_f32 v[84:85], v[84:85], s[8:9]
    v_pk_mul_f32 v[86:87], v[86:87], s[8:9]
    v_mul_u32_u24 v93, 20, v6
    s_movk_i32 s7, 320
    v_mad_u32_u24 v93, v7, s7, v93
    s_lshl_b32 s7, s3, 2
    v_add_u32 v93, s7, v93
    v_and_b32 v94, 3, v6
    v_lshl_add_u32 v94, v7, 3, v94
    v_mul_u32_u24 v94, 80, v94
    v_lshrrev_b32 v95, 2, v6
    s_movk_i32 s7, 5184
    v_mad_u32_u24 v94, v95, s7, v94
    s_lshl_b32 s7, s3, 4
    s_add_u32 s7, s7, 15360
    v_add_u32 v94, s7, v94
K1_L2:
    s_and_b32 s11, s3, 3
    s_lshr_b32 s10, s3, 2
    s_mul_i32 s14, s4, 16384
    s_lshl_b32 s7, s11, 12
    s_add_u32 s14, s14, s7
    s_lshl_b32 s7, s10, 11
    s_add_u32 s14, s14, s7
    s_add_u32 s14, s14, 1048576
    v_bfe_u32 v96, v1, 2, 3
    v_lshrrev_b32 v2, 5, v1
    v_lshl_add_u32 v96, v2, 4, v96
    v_and_b32 v2, 3, v1
    v_lshlrev_b32 v2, 4, v2
    v_lshl_add_u32 v88, v96, 6, v2
    v_bfe_u32 v2, v1, 1, 1
    v_lshl_add_u32 v96, v2, 3, v96
    s_lshl_b32 s7, s10, 5
    v_add_u32 v96, s7, v96
    v_and_b32 v97, 1, v1
    v_sub_u32 v2, 64, v96
    v_and_b32 v2, 63, v2
    s_cmp_eq_u32 s11, 0
    s_cselect_b32 vcc_lo, 0xaaaaaaaa, 0
    s_mov_b32 vcc_hi, vcc_lo
    v_cndmask_b32 v96, v96, v2, vcc
    v_cvt_f32_u32 v114, v97
    v_fma_f32 v114, v114, -2.0, 1.0
    s_mul_i32 s7, s11, 5184
    s_add_u32 s7, s7, 15360
    v_mul_u32_u24 v95, 80, v96
    v_add_u32 v95, s7, v95
    s_mov_b32 s70, 0x3e9e377a
    s_mov_b32 s71, 0xbf4f1bbd
    s_mov_b32 s72, 0x3f737871
    s_mov_b32 s73, 0x3f167918
    s_cmp_ge_u32 s43, 40
    s_cbranch_scc1 F_NG
    s_waitcnt vmcnt(11)
    v_lshlrev_b32 v28, 16, v28
    v_lshlrev_b32 v29, 16, v29
    v_lshlrev_b32 v30, 16, v30
    v_lshlrev_b32 v31, 16, v31
    v_lshlrev_b32 v32, 16, v32
    v_mul_f32 v34, 0xbfb8aa3b, v28
    v_mul_f32 v35, 0xbfb8aa3b, v29
    v_mul_f32 v36, 0xbfb8aa3b, v30
    v_mul_f32 v37, 0xbfb8aa3b, v31
    v_mul_f32 v38, 0xbfb8aa3b, v32
    v_exp_f32 v34, v34
    v_exp_f32 v35, v35
    v_exp_f32 v36, v36
    v_exp_f32 v37, v37
    v_exp_f32 v38, v38
    v_add_f32 v34, 1.0, v34
    v_add_f32 v35, 1.0, v35
    v_add_f32 v36, 1.0, v36
    v_add_f32 v37, 1.0, v37
    v_add_f32 v38, 1.0, v38
    v_rcp_f32 v34, v34
    v_rcp_f32 v35, v35
    v_rcp_f32 v36, v36
    v_rcp_f32 v37, v37
    v_rcp_f32 v38, v38
    v_mul_f32 v28, v28, v34
    v_mul_f32 v29, v29, v35
    v_mul_f32 v30, v30, v36
    v_mul_f32 v31, v31, v37
    v_mul_f32 v32, v32, v38
    v_cvt_pk_bf16_f32 v28, 0, v28
    v_cvt_pk_bf16_f32 v29, 0, v29
    v_cvt_pk_bf16_f32 v30, 0, v30
    v_cvt_pk_bf16_f32 v31, 0, v31
    v_cvt_pk_bf16_f32 v32, 0, v32
    v_lshrrev_b32 v34, 16, v28
    v_lshrrev_b32 v35, 16, v29
    v_lshrrev_b32 v36, 16, v30
    v_lshrrev_b32 v37, 16, v31
    v_lshrrev_b32 v38, 16, v32
    s_waitcnt vmcnt(10)
    v_dot2_f32_bf16 v48, v8, v34, 0
    v_dot2_f32_bf16 v49, v8, v28, 0
    v_dot2_f32_bf16 v50, v9, v34, 0
    v_dot2_f32_bf16 v51, v9, v28, 0
    v_dot2_f32_bf16 v52, v10, v34, 0
    v_dot2_f32_bf16 v53, v10, v28, 0
    v_dot2_f32_bf16 v54, v11, v34, 0
    v_dot2_f32_bf16 v55, v11, v28, 0
    s_waitcnt vmcnt(9)
    v_dot2_f32_bf16 v56, v12, v35, 0
    v_dot2_f32_bf16 v57, v12, v29, 0
    v_dot2_f32_bf16 v58, v13, v35, 0
    v_dot2_f32_bf16 v59, v13, v29, 0
    v_dot2_f32_bf16 v60, v14, v35, 0
    v_dot2_f32_bf16 v61, v14, v29, 0
    v_dot2_f32_bf16 v62, v15, v35, 0
    v_dot2_f32_bf16 v63, v15, v29, 0
    s_waitcnt vmcnt(8)
    v_dot2_f32_bf16 v48, v16, v36, v48
    v_dot2_f32_bf16 v49, v16, v30, v49
    v_dot2_f32_bf16 v50, v17, v36, v50
    v_dot2_f32_bf16 v51, v17, v30, v51
    v_dot2_f32_bf16 v52, v18, v36, v52
    v_dot2_f32_bf16 v53, v18, v30, v53
    v_dot2_f32_bf16 v54, v19, v36, v54
    v_dot2_f32_bf16 v55, v19, v30, v55
    s_waitcnt vmcnt(7)
    v_dot2_f32_bf16 v56, v20, v37, v56
    v_dot2_f32_bf16 v57, v20, v31, v57
    v_dot2_f32_bf16 v58, v21, v37, v58
    v_dot2_f32_bf16 v59, v21, v31, v59
    v_dot2_f32_bf16 v60, v22, v37, v60
    v_dot2_f32_bf16 v61, v22, v31, v61
    v_dot2_f32_bf16 v62, v23, v37, v62
    v_dot2_f32_bf16 v63, v23, v31, v63
    s_waitcnt vmcnt(6)
    v_dot2_f32_bf16 v48, v24, v38, v48
    v_dot2_f32_bf16 v49, v24, v32, v49
    v_dot2_f32_bf16 v50, v25, v38, v50
    v_dot2_f32_bf16 v51, v25, v32, v51
    v_dot2_f32_bf16 v52, v26, v38, v52
    v_dot2_f32_bf16 v53, v26, v32, v53
    v_dot2_f32_bf16 v54, v27, v38, v54
    v_dot2_f32_bf16 v55, v27, v32, v55
    v_add_f32 v8, v48, v56
    v_add_f32 v9, v49, v57
    v_add_f32 v10, v50, v58
    v_add_f32 v11, v51, v59
    v_add_f32 v12, v52, v60
    v_add_f32 v13, v53, v61
    v_add_f32 v14, v54, v62
    v_add_f32 v15, v55, v63
    v_permlane32_swap_b32 v8, v12
    v_permlane32_swap_b32 v9, v13
    v_permlane32_swap_b32 v10, v14
    v_permlane32_swap_b32 v11, v15
    v_add_f32 v8, v8, v12
    v_add_f32 v9, v9, v13
    v_add_f32 v10, v10, v14
    v_add_f32 v11, v11, v15
    s_nop 0
    v_permlane16_swap_b32 v8, v10
    v_permlane16_swap_b32 v9, v11
    v_add_f32 v8, v8, v10
    v_add_f32 v9, v9, v11
    s_nop 0
    v_add_f32_dpp v8, v8, v8 row_ror:8 row_mask:0xf bank_mask:0xf
    v_add_f32_dpp v9, v9, v9 row_ror:8 row_mask:0xf bank_mask:0xf
    ds_write_b64 v102, v[8:9] offset:15360
    s_waitcnt lgkmcnt(0)
    s_barrier
    s_cmp_ge_u32 s3, 2
    s_cbranch_scc1 F_NG
    s_add_u32 s7, s1, 1
    s_bfe_u32 s74, s7, 0x80000
    s_bfe_u32 s75, s7, 0x80008
    s_bfe_u32 s76, s7, 0x80010
    s_bfe_u32 s77, s7, 0x80018
    s_movk_i32 s8, 0xff00
    s_movk_i32 s12, 10240
    v_lshlrev_b32 v2, 4, v6
    s_lshl_b32 s9, s43, 8
    s_mul_i32 s10, s3, 40960
    s_add_u32 s9, s9, s10
    s_add_u32 s9, s9, 655360
    v_mad_u32_u24 v4, v7, s12, v2
    v_mov_b32 v40, s74
    v_mov_b32 v41, s75
    v_mov_b32 v42, s76
    v_mov_b32 v43, s77
    ds_read_b128 v[8:11], v2 offset:15360
    ds_read_b128 v[12:15], v2 offset:15616
    ds_read_b128 v[16:19], v2 offset:15872
    ds_read_b128 v[20:23], v2 offset:16128
    ds_read_b128 v[24:27], v2 offset:16384
    ds_read_b128 v[28:31], v2 offset:16640
    ds_read_b128 v[32:35], v2 offset:16896
    ds_read_b128 v[36:39], v2 offset:17152
    s_waitcnt lgkmcnt(6)
    v_pk_add_f32 v[8:9], v[8:9], v[12:13]
    v_pk_add_f32 v[10:11], v[10:11], v[14:15]
    s_waitcnt lgkmcnt(4)
    v_pk_add_f32 v[16:17], v[16:17], v[20:21]
    v_pk_add_f32 v[18:19], v[18:19], v[22:23]
    s_waitcnt lgkmcnt(2)
    v_pk_add_f32 v[24:25], v[24:25], v[28:29]
    v_pk_add_f32 v[26:27], v[26:27], v[30:31]
    s_waitcnt lgkmcnt(0)
    v_pk_add_f32 v[32:33], v[32:33], v[36:37]
    v_pk_add_f32 v[34:35], v[34:35], v[38:39]
    v_pk_add_f32 v[8:9], v[8:9], v[16:17]
    v_pk_add_f32 v[10:11], v[10:11], v[18:19]
    v_pk_add_f32 v[24:25], v[24:25], v[32:33]
    v_pk_add_f32 v[26:27], v[26:27], v[34:35]
    v_pk_add_f32 v[8:9], v[8:9], v[24:25]
    v_pk_add_f32 v[10:11], v[10:11], v[26:27]
    v_add_u32 v8, 128, v8
    v_add_u32 v9, 128, v9
    v_add_u32 v10, 128, v10
    v_add_u32 v11, 128, v11
    v_and_or_b32 v8, v8, s8, v40
    v_and_or_b32 v9, v9, s8, v41
    v_and_or_b32 v10, v10, s8, v42
    v_and_or_b32 v11, v11, s8, v43
    buffer_store_dwordx4 v[8:11], v4, s[44:47], s9 offen sc1
F_NG:
    s_mul_i32 s7, s3, 1280
    v_add_u32 v37, s7, v5
    v_add_u32 v15, s7, v3
    s_waitcnt vmcnt(5) lgkmcnt(0)
    s_cmp_lt_u32 s43, 40
    s_cselect_b32 s63, s3, 8
    s_cmp_lt_u32 s63, 2
    s_cselect_b32 s63, 0, 1
    s_cmp_eq_u32 s63, 0
    s_cbranch_scc1 F_XIN
    s_waitcnt vmcnt(4)
F_XIN:
    s_cmp_ge_u32 s2, 200
    s_cbranch_scc1 F_NB
    buffer_load_ushort v40, v101, s[64:67], s87 offen offset:0
    buffer_load_ushort v41, v101, s[64:67], s87 offen offset:128
    buffer_load_dwordx4 v[28:31], v100, s[52:55], s86 offen offset:2560 nt
    s_add_u32 s86, s86, 491520
    buffer_load_dwordx4 v[32:35], v100, s[52:55], s86 offen offset:2560 nt
F_NB:
    s_add_u32 s1, s1, 1
    v_lshlrev_b32 v16, 16, v120
    v_and_b32 v17, 0xffff0000, v120
    v_lshlrev_b32 v18, 16, v121
    v_and_b32 v19, 0xffff0000, v121
    v_lshlrev_b32 v20, 16, v122
    v_and_b32 v21, 0xffff0000, v122
    v_lshlrev_b32 v22, 16, v123
    v_and_b32 v23, 0xffff0000, v123
    v_lshlrev_b32 v24, 16, v124
    v_and_b32 v25, 0xffff0000, v124
    v_pk_add_f32 v[48:49], v[16:17], v[18:19]
    v_pk_add_f32 v[50:51], v[20:21], v[22:23]
    v_pk_add_f32 v[48:49], v[48:49], v[24:25]
    v_pk_add_f32 v[48:49], v[48:49], v[50:51]
    v_add_f32 v44, v48, v49
    s_nop 1
    v_add_f32_dpp v44, v44, v44 row_ror:8 row_mask:0xf bank_mask:0xf
    s_nop 1
    v_add_f32_dpp v44, v44, v44 row_ror:4 row_mask:0xf bank_mask:0xf
    s_nop 1
    v_add_f32_dpp v44, v44, v44 row_ror:2 row_mask:0xf bank_mask:0xf
    s_nop 1
    v_add_f32_dpp v44, v44, v44 row_ror:1 row_mask:0xf bank_mask:0xf
    s_nop 1
    v_add_f32_dpp v44, v44, v44 row_bcast:15 row_mask:0xa bank_mask:0xf
    s_nop 1
    v_add_f32_dpp v44, v44, v44 row_bcast:31 row_mask:0xc bank_mask:0xf
    v_mul_f32 v44, 0x3acccccd, v44
    s_nop 0
    v_readlane_b32 s12, v44, 63
    s_nop 1
    v_pk_add_f32 v[48:49], v[16:17], s[12:13] op_sel_hi:[1,0] neg_lo:[0,1] neg_hi:[0,1]
    v_pk_add_f32 v[50:51], v[18:19], s[12:13] op_sel_hi:[1,0] neg_lo:[0,1] neg_hi:[0,1]
    v_pk_add_f32 v[52:53], v[20:21], s[12:13] op_sel_hi:[1,0] neg_lo:[0,1] neg_hi:[0,1]
    v_pk_add_f32 v[54:55], v[22:23], s[12:13] op_sel_hi:[1,0] neg_lo:[0,1] neg_hi:[0,1]
    v_pk_add_f32 v[56:57], v[24:25], s[12:13] op_sel_hi:[1,0] neg_lo:[0,1] neg_hi:[0,1]
    v_pk_mul_f32 v[58:59], v[48:49], v[48:49]
    v_pk_mul_f32 v[60:61], v[50:51], v[50:51]
    v_pk_fma_f32 v[58:59], v[52:53], v[52:53], v[58:59]
    v_pk_fma_f32 v[60:61], v[54:55], v[54:55], v[60:61]
    v_pk_fma_f32 v[58:59], v[56:57], v[56:57], v[58:59]
    v_pk_add_f32 v[58:59], v[58:59], v[60:61]
    v_add_f32 v45, v58, v59
    v_cvt_pk_bf16_f32 v44, 0, v44
    s_nop 0
    v_add_f32_dpp v45, v45, v45 row_ror:8 row_mask:0xf bank_mask:0xf
    s_nop 1
    v_add_f32_dpp v45, v45, v45 row_ror:4 row_mask:0xf bank_mask:0xf
    s_nop 1
    v_add_f32_dpp v45, v45, v45 row_ror:2 row_mask:0xf bank_mask:0xf
    s_nop 1
    v_add_f32_dpp v45, v45, v45 row_ror:1 row_mask:0xf bank_mask:0xf
    s_nop 1
    v_add_f32_dpp v45, v45, v45 row_bcast:15 row_mask:0xa bank_mask:0xf
    s_nop 1
    v_add_f32_dpp v45, v45, v45 row_bcast:31 row_mask:0xc bank_mask:0xf
    v_mul_f32 v45, 0x3acccccd, v45
    v_cvt_pk_bf16_f32 v45, 0, v45
    v_add_f32 v45, 0x3727c5ac, v45
    v_cvt_pk_bf16_f32 v45, 0, v45
    v_sqrt_f32 v45, v45
    s_nop 0
    v_cvt_pk_bf16_f32 v45, 0, v45
    v_rcp_f32 v45, v45
    v_readlane_b32 s12, v44, 63
    v_readlane_b32 s13, v45, 63
    s_nop 1
    v_pk_add_f32 v[16:17], v[16:17], s[12:13] op_sel_hi:[1,0] neg_lo:[0,1] neg_hi:[0,1]
    v_pk_add_f32 v[18:19], v[18:19], s[12:13] op_sel_hi:[1,0] neg_lo:[0,1] neg_hi:[0,1]
    v_pk_add_f32 v[20:21], v[20:21], s[12:13] op_sel_hi:[1,0] neg_lo:[0,1] neg_hi:[0,1]
    v_pk_add_f32 v[22:23], v[22:23], s[12:13] op_sel_hi:[1,0] neg_lo:[0,1] neg_hi:[0,1]
    v_pk_add_f32 v[24:25], v[24:25], s[12:13] op_sel_hi:[1,0] neg_lo:[0,1] neg_hi:[0,1]
    v_cvt_pk_bf16_f32 v16, 0, v16
    v_cvt_pk_bf16_f32 v17, 0, v17
    v_cvt_pk_bf16_f32 v18, 0, v18
    v_cvt_pk_bf16_f32 v19, 0, v19
    v_cvt_pk_bf16_f32 v20, 0, v20
    v_cvt_pk_bf16_f32 v21, 0, v21
    v_cvt_pk_bf16_f32 v22, 0, v22
    v_cvt_pk_bf16_f32 v23, 0, v23
    v_cvt_pk_bf16_f32 v24, 0, v24
    v_cvt_pk_bf16_f32 v25, 0, v25
    v_pk_mul_f32 v[16:17], v[16:17], s[12:13] op_sel:[0,1] op_sel_hi:[1,1]
    v_pk_mul_f32 v[18:19], v[18:19], s[12:13] op_sel:[0,1] op_sel_hi:[1,1]
    v_pk_mul_f32 v[20:21], v[20:21], s[12:13] op_sel:[0,1] op_sel_hi:[1,1]
    v_pk_mul_f32 v[22:23], v[22:23], s[12:13] op_sel:[0,1] op_sel_hi:[1,1]
    v_pk_mul_f32 v[24:25], v[24:25], s[12:13] op_sel:[0,1] op_sel_hi:[1,1]
    v_cvt_pk_bf16_f32 v8, v16, v17
    v_cvt_pk_bf16_f32 v9, v18, v19
    v_cvt_pk_bf16_f32 v10, v20, v21
    v_cvt_pk_bf16_f32 v11, v22, v23
    v_cvt_pk_bf16_f32 v12, v24, v25
    ds_write_b128 v37, v[8:11]
    ds_write_b32 v15, v12 offset:1024
    v_lshlrev_b32 v4, 4, v0
    v_add_u32 v4, -3072, v4
    v_cmp_le_i32 vcc, 2560, v4
    s_nop 1
    v_cndmask_b32 v38, 0, 1.0, vcc
    v_cndmask_b32 v36, 0, 5, vcc
    s_movk_i32 s7, 5128
    v_mov_b32 v39, s7
    v_cndmask_b32 v39, 0, v39, vcc
    s_movk_i32 s7, 10248
    v_lshl_add_u32 v2, v4, 1, s7
    v_sub_u32 v39, v2, v39
    s_mov_b32 s60, 0x05040302
    s_mov_b32 s61, 0x05040100
    s_cmp_ge_u32 s2, 200
    s_cbranch_scc1 F_NB2
    s_waitcnt vmcnt(2)
    v_lshlrev_b32 v40, 16, v40
    v_lshlrev_b32 v41, 16, v41
    v_mul_f32 v42, 0xbfb8aa3b, v40
    v_mul_f32 v43, 0xbfb8aa3b, v41
    v_exp_f32 v42, v42
    v_exp_f32 v43, v43
    v_add_f32 v42, 1.0, v42
    v_add_f32 v43, 1.0, v43
    v_rcp_f32 v42, v42
    v_rcp_f32 v43, v43
    v_mul_f32 v40, v40, v42
    v_mul_f32 v41, v41, v43
    v_cvt_pk_bf16_f32 v40, 0, v40
    v_cvt_pk_bf16_f32 v41, 0, v41
    v_lshrrev_b32 v42, 16, v40
    v_lshrrev_b32 v43, 16, v41
    s_waitcnt vmcnt(1)
    v_dot2_f32_bf16 v48, v28, v42, 0
    v_dot2_f32_bf16 v49, v28, v40, 0
    v_dot2_f32_bf16 v50, v29, v42, 0
    v_dot2_f32_bf16 v51, v29, v40, 0
    v_dot2_f32_bf16 v52, v30, v42, 0
    v_dot2_f32_bf16 v53, v30, v40, 0
    v_dot2_f32_bf16 v54, v31, v42, 0
    v_dot2_f32_bf16 v55, v31, v40, 0
    s_waitcnt vmcnt(0)
    v_dot2_f32_bf16 v56, v32, v43, 0
    v_dot2_f32_bf16 v57, v32, v41, 0
    v_dot2_f32_bf16 v58, v33, v43, 0
    v_dot2_f32_bf16 v59, v33, v41, 0
    v_dot2_f32_bf16 v60, v34, v43, 0
    v_dot2_f32_bf16 v61, v34, v41, 0
    v_dot2_f32_bf16 v62, v35, v43, 0
    v_dot2_f32_bf16 v63, v35, v41, 0
    v_add_f32 v28, v48, v56
    v_add_f32 v29, v49, v57
    v_add_f32 v30, v50, v58
    v_add_f32 v31, v51, v59
    v_add_f32 v32, v52, v60
    v_add_f32 v33, v53, v61
    v_add_f32 v34, v54, v62
    v_add_f32 v35, v55, v63
    v_permlane32_swap_b32 v28, v32
    v_permlane32_swap_b32 v29, v33
    v_permlane32_swap_b32 v30, v34
    v_permlane32_swap_b32 v31, v35
    v_add_f32 v28, v28, v32
    v_add_f32 v29, v29, v33
    v_add_f32 v30, v30, v34
    v_add_f32 v31, v31, v35
    s_nop 0
    v_permlane16_swap_b32 v28, v30
    v_permlane16_swap_b32 v29, v31
    v_add_f32 v28, v28, v30
    v_add_f32 v29, v29, v31
    s_nop 0
    v_add_f32_dpp v28, v28, v28 row_ror:8 row_mask:0xf bank_mask:0xf
    v_add_f32_dpp v29, v29, v29 row_ror:8 row_mask:0xf bank_mask:0xf
    ds_write_b64 v102, v[28:29] offset:15360
F_NB2:
    s_waitcnt vmcnt(2) lgkmcnt(0)
    s_cmp_eq_u32 s63, 0
    s_cbranch_scc1 F_TIN
    s_waitcnt vmcnt(1)
F_TIN:
    s_barrier
    s_cmp_lg_u32 s3, 1
    s_cbranch_scc1 F_NB3
    s_cmp_ge_u32 s2, 200
    s_cbranch_scc1 F_NB3
    s_lshl_b32 s9, s2, 8
    s_add_u32 s9, s9, 278528
    s_bfe_u32 s74, s1, 0x80000
    s_bfe_u32 s75, s1, 0x80008
    s_bfe_u32 s76, s1, 0x80010
    s_bfe_u32 s77, s1, 0x80018
    v_mov_b32 v40, s74
    v_mov_b32 v41, s75
    v_mov_b32 v42, s76
    v_mov_b32 v43, s77
    s_mov_b64 exec, 0xffff
    ds_read_b128 v[8:11], v5 offset:15360
    ds_read_b128 v[12:15], v5 offset:15616
    ds_read_b128 v[16:19], v5 offset:15872
    ds_read_b128 v[20:23], v5 offset:16128
    ds_read_b128 v[24:27], v5 offset:16384
    ds_read_b128 v[28:31], v5 offset:16640
    ds_read_b128 v[32:35], v5 offset:16896
    ds_read_b128 v[36:39], v5 offset:17152
    s_waitcnt lgkmcnt(6)
    v_pk_add_f32 v[8:9], v[8:9], v[12:13]
    v_pk_add_f32 v[10:11], v[10:11], v[14:15]
    s_waitcnt lgkmcnt(4)
    v_pk_add_f32 v[16:17], v[16:17], v[20:21]
    v_pk_add_f32 v[18:19], v[18:19], v[22:23]
    s_waitcnt lgkmcnt(2)
    v_pk_add_f32 v[24:25], v[24:25], v[28:29]
    v_pk_add_f32 v[26:27], v[26:27], v[30:31]
    s_waitcnt lgkmcnt(0)
    v_pk_add_f32 v[32:33], v[32:33], v[36:37]
    v_pk_add_f32 v[34:35], v[34:35], v[38:39]
    v_pk_add_f32 v[8:9], v[8:9], v[16:17]
    v_pk_add_f32 v[10:11], v[10:11], v[18:19]
    v_pk_add_f32 v[24:25], v[24:25], v[32:33]
    v_pk_add_f32 v[26:27], v[26:27], v[34:35]
    v_pk_add_f32 v[8:9], v[8:9], v[24:25]
    v_pk_add_f32 v[10:11], v[10:11], v[26:27]
    s_movk_i32 s7, 0xff00
    v_add_u32 v8, 128, v8
    v_add_u32 v9, 128, v9
    v_add_u32 v10, 128, v10
    v_add_u32 v11, 128, v11
    v_and_or_b32 v44, v8, s7, v40
    v_and_or_b32 v45, v9, s7, v41
    v_and_or_b32 v46, v10, s7, v42
    v_and_or_b32 v47, v11, s7, v43
    buffer_store_dwordx4 v[44:47], v5, s[44:47], s9 offen sc1
    s_mov_b64 exec, -1
    s_nop 1
F_NB3:
    s_cmp_ge_u32 s3, 5
    s_cbranch_scc1 F_NR
    ds_read2st64_b32 v[8:9], v93 offset0:0 offset1:5
    ds_read2st64_b32 v[10:11], v93 offset0:10 offset1:15
    ds_read2st64_b32 v[12:13], v93 offset0:20 offset1:25
    ds_read2st64_b32 v[14:15], v93 offset0:30 offset1:35
    ds_read_b128 v[64:67], v5 offset:42240
    ds_read_b128 v[68:71], v5 offset:43264
    ds_read_b128 v[40:43], v5 offset:36096
    ds_read_b128 v[44:47], v5 offset:37120
    ds_read_b128 v[48:51], v5 offset:38144
    ds_read_b128 v[52:55], v5 offset:39168
    ds_read_b128 v[56:59], v5 offset:40192
    ds_read_b128 v[60:63], v5 offset:41216
    v_lshlrev_b32 v93, 2, v93
    s_waitcnt lgkmcnt(8)
    v_lshlrev_b32 v96, 16, v8
    v_and_b32 v104, 0xffff0000, v8
    v_lshlrev_b32 v97, 16, v9
    v_and_b32 v105, 0xffff0000, v9
    v_lshlrev_b32 v98, 16, v10
    v_and_b32 v106, 0xffff0000, v10
    v_lshlrev_b32 v99, 16, v11
    v_and_b32 v107, 0xffff0000, v11
    v_lshlrev_b32 v100, 16, v12
    v_and_b32 v108, 0xffff0000, v12
    v_lshlrev_b32 v101, 16, v13
    v_and_b32 v109, 0xffff0000, v13
    v_lshlrev_b32 v102, 16, v14
    v_and_b32 v110, 0xffff0000, v14
    v_lshlrev_b32 v103, 16, v15
    v_and_b32 v111, 0xffff0000, v15
    s_cmp_lt_u32 s3, 3
    s_cbranch_scc1 F_MD
F_NR:
    s_and_b32 s8, s2, 7
    s_mul_i32 s8, s8, 10240
    s_add_u32 s8, s8, 655360
    s_add_u32 s9, s8, 5120
    s_bfe_u32 s74, s1, 0x80000
    s_bfe_u32 s75, s1, 0x80008
    s_bfe_u32 s76, s1, 0x80010
    s_bfe_u32 s77, s1, 0x80018
    s_sleep 8
E0_NS:
    s_mov_b32 s15, 65536
    buffer_load_dwordx4 v[16:19], v4, s[44:47], s8 offen
    buffer_load_dwordx4 v[20:23], v4, s[44:47], s9 offen
    s_waitcnt vmcnt(0)
    s_branch E0_CHK
E0_LOOP:
    buffer_load_dwordx4 v[16:19], v4, s[44:47], s8 offen sc1
    buffer_load_dwordx4 v[20:23], v4, s[44:47], s9 offen sc1
    s_waitcnt vmcnt(0)
E0_CHK:
    v_xor_b32 v16, s74, v16
    v_xor_b32 v17, s75, v17
    v_xor_b32 v18, s76, v18
    v_xor_b32 v19, s77, v19
    v_xor_b32 v20, s74, v20
    v_xor_b32 v21, s75, v21
    v_xor_b32 v22, s76, v22
    v_xor_b32 v23, s77, v23
    v_or3_b32 v8, v16, v17, v18
    v_or3_b32 v9, v19, v20, v21
    v_or3_b32 v10, v8, v9, v22
    v_or_b32 v11, v10, v23
    v_and_b32 v9, 255, v11
    v_cmp_ne_u32 vcc, 0, v9
    s_sub_u32 s15, s15, 1
    s_cbranch_scc1 E0_DONE
    s_cbranch_vccz E0_DONE
    s_mov_b64 exec, vcc
    s_branch E0_LOOP
E0_DONE:
    s_mov_b64 exec, -1
    v_pk_add_f32 v[16:17], v[16:17], v[20:21]
    v_pk_add_f32 v[18:19], v[18:19], v[22:23]
    v_cvt_pk_bf16_f32 v16, 0, v16
    v_cvt_pk_bf16_f32 v17, 0, v17
    v_cvt_pk_bf16_f32 v18, 0, v18
    v_cvt_pk_bf16_f32 v19, 0, v19
    v_pk_add_f32 v[16:17], v[16:17], v[38:39] op_sel_hi:[1,0]
    v_pk_add_f32 v[18:19], v[18:19], v[38:39] op_sel_hi:[1,0]
    v_cvt_pk_bf16_f32 v16, 0, v16
    v_cvt_pk_bf16_f32 v17, 0, v17
    v_cvt_pk_bf16_f32 v18, 0, v18
    v_cvt_pk_bf16_f32 v19, 0, v19
    ds_write2_b64 v39, v[16:17], v[18:19] offset0:0 offset1:2
    v_max3_f32 v20, |v16|, |v17|, |v18|
    v_max_f32 v20, v20, |v19|
    v_lshrrev_b32 v20, 23, v20
    v_add_u32 v20, v36, v20
    v_mov_b32 v2, 0
    s_nop 0
    v_max_u32_dpp v20, v20, v20 row_ror:8 row_mask:0xf bank_mask:0xf
    s_nop 1
    v_max_u32_dpp v20, v20, v20 row_ror:4 row_mask:0xf bank_mask:0xf
    s_nop 1
    v_max_u32_dpp v20, v20, v20 row_ror:2 row_mask:0xf bank_mask:0xf
    s_nop 1
    v_max_u32_dpp v20, v20, v20 row_ror:1 row_mask:0xf bank_mask:0xf
    s_nop 1
    v_max_u32_dpp v20, v20, v20 row_bcast:15 row_mask:0xa bank_mask:0xf
    s_nop 1
    v_max_u32_dpp v20, v20, v20 row_bcast:31 row_mask:0xc bank_mask:0xf
    s_mov_b32 exec_lo, 0
    s_mov_b32 exec_hi, 0x80000000
    ds_max_u32 v2, v20 offset:36032
    s_mov_b64 exec, -1
F_MD:
    v_mov_b32 v2, 0
    s_waitcnt lgkmcnt(0)
    s_barrier
    ds_read_b32 v12, v2 offset:36032
    s_cmp_ge_u32 s3, 5
    s_cbranch_scc1 K1_BG
    ds_read_b128 v[8:11], v93 offset:10240
    s_waitcnt lgkmcnt(0)
    v_pk_mul_f32 v[96:97], v[96:97], v[8:9] op_sel_hi:[1,0]
    v_pk_mul_f32 v[98:99], v[98:99], v[8:9] op_sel_hi:[1,0]
    v_pk_mul_f32 v[100:101], v[100:101], v[8:9] op_sel_hi:[1,0]
    v_pk_mul_f32 v[102:103], v[102:103], v[8:9] op_sel_hi:[1,0]
    v_cvt_pk_bf16_f32 v96, 0, v96
    v_cvt_pk_bf16_f32 v97, 0, v97
    v_cvt_pk_bf16_f32 v98, 0, v98
    v_cvt_pk_bf16_f32 v99, 0, v99
    v_cvt_pk_bf16_f32 v100, 0, v100
    v_cvt_pk_bf16_f32 v101, 0, v101
    v_cvt_pk_bf16_f32 v102, 0, v102
    v_cvt_pk_bf16_f32 v103, 0, v103
    v_pk_add_f32 v[96:97], v[96:97], v[10:11] op_sel_hi:[1,0]
    v_pk_add_f32 v[98:99], v[98:99], v[10:11] op_sel_hi:[1,0]
    v_pk_add_f32 v[100:101], v[100:101], v[10:11] op_sel_hi:[1,0]
    v_pk_add_f32 v[102:103], v[102:103], v[10:11] op_sel_hi:[1,0]
    v_cvt_pk_bf16_f32 v16, v96, v97
    v_cvt_pk_bf16_f32 v17, v98, v99
    v_cvt_pk_bf16_f32 v18, v100, v101
    v_cvt_pk_bf16_f32 v19, v102, v103
    v_readfirstlane_b32 s8, v12
    s_nop 0
    v_mfma_f32_16x16x32_bf16 v[24:27], v[16:19], v[44:47], 0
    v_mfma_f32_16x16x32_bf16 v[28:31], v[16:19], v[52:55], 0
    v_mfma_f32_16x16x32_bf16 v[24:27], v[16:19], v[40:43], v[24:27]
    v_mfma_f32_16x16x32_bf16 v[28:31], v[16:19], v[48:51], v[28:31]
    s_min_u32 s0, s8, 255
    s_sub_u32 s9, 256, s0
    s_lshl_b32 s62, s9, 23
    v_pk_mul_f32 v[104:105], v[8:9], v[104:105] op_sel:[1,0] op_sel_hi:[1,1]
    v_pk_mul_f32 v[106:107], v[8:9], v[106:107] op_sel:[1,0] op_sel_hi:[1,1]
    v_pk_mul_f32 v[108:109], v[8:9], v[108:109] op_sel:[1,0] op_sel_hi:[1,1]
    v_pk_mul_f32 v[110:111], v[8:9], v[110:111] op_sel:[1,0] op_sel_hi:[1,1]
    v_cvt_pk_bf16_f32 v104, 0, v104
    v_cvt_pk_bf16_f32 v105, 0, v105
    v_cvt_pk_bf16_f32 v106, 0, v106
    v_cvt_pk_bf16_f32 v107, 0, v107
    v_cvt_pk_bf16_f32 v108, 0, v108
    v_cvt_pk_bf16_f32 v109, 0, v109
    v_cvt_pk_bf16_f32 v110, 0, v110
    v_cvt_pk_bf16_f32 v111, 0, v111
    v_pk_add_f32 v[104:105], v[10:11], v[104:105] op_sel:[1,0] op_sel_hi:[1,1]
    v_pk_add_f32 v[106:107], v[10:11], v[106:107] op_sel:[1,0] op_sel_hi:[1,1]
    v_pk_add_f32 v[108:109], v[10:11], v[108:109] op_sel:[1,0] op_sel_hi:[1,1]
    v_pk_add_f32 v[110:111], v[10:11], v[110:111] op_sel:[1,0] op_sel_hi:[1,1]
    v_cvt_pk_bf16_f32 v20, v104, v105
    v_cvt_pk_bf16_f32 v21, v106, v107
    v_cvt_pk_bf16_f32 v22, v108, v109
    v_cvt_pk_bf16_f32 v23, v110, v111
    s_nop 1
    v_mfma_f32_16x16x32_bf16 v[32:35], v[20:23], v[44:47], 0
    v_mfma_f32_16x16x32_bf16 v[36:39], v[20:23], v[52:55], 0
    v_mfma_f32_16x16x32_bf16 v[32:35], v[20:23], v[40:43], v[32:35]
    v_mfma_f32_16x16x32_bf16 v[36:39], v[20:23], v[48:51], v[36:39]
    v_pk_mul_f32 v[64:65], v[64:65], s[62:63] op_sel_hi:[1,0]
    v_pk_mul_f32 v[66:67], v[66:67], s[62:63] op_sel_hi:[1,0]
    v_pk_mul_f32 v[68:69], v[68:69], s[62:63] op_sel_hi:[1,0]
    v_pk_mul_f32 v[70:71], v[70:71], s[62:63] op_sel_hi:[1,0]
    v_pk_mul_f32 v[96:97], v[24:25], v[64:65]
    v_pk_mul_f32 v[100:101], v[28:29], v[64:65]
    v_pk_mul_f32 v[98:99], v[26:27], v[66:67]
    v_pk_mul_f32 v[102:103], v[30:31], v[66:67]
    v_pk_fma_f32 v[96:97], v[28:29], v[68:69], v[96:97] neg_lo:[1,0,0] neg_hi:[1,0,0]
    v_pk_fma_f32 v[100:101], v[24:25], v[68:69], v[100:101]
    v_pk_fma_f32 v[98:99], v[30:31], v[70:71], v[98:99] neg_lo:[1,0,0] neg_hi:[1,0,0]
    v_pk_fma_f32 v[102:103], v[26:27], v[70:71], v[102:103]
    v_cvt_pk_f16_f32 v8, v96, v100
    v_cvt_pk_f16_f32 v9, v97, v101
    v_cvt_pk_f16_f32 v10, v98, v102
    v_cvt_pk_f16_f32 v11, v99, v103
    s_nop 1
    v_mfma_f32_16x16x32_f16 v[104:107], v[56:59], v[8:11], 0
    v_mfma_f32_16x16x32_f16 v[108:111], v[60:63], v[8:11], 0
    v_pk_mul_f32 v[96:97], v[32:33], v[64:65]
    v_pk_mul_f32 v[100:101], v[36:37], v[64:65]
    v_pk_mul_f32 v[98:99], v[34:35], v[66:67]
    v_pk_mul_f32 v[102:103], v[38:39], v[66:67]
    v_pk_fma_f32 v[96:97], v[36:37], v[68:69], v[96:97] neg_lo:[1,0,0] neg_hi:[1,0,0]
    v_pk_fma_f32 v[100:101], v[32:33], v[68:69], v[100:101]
    v_pk_fma_f32 v[98:99], v[38:39], v[70:71], v[98:99] neg_lo:[1,0,0] neg_hi:[1,0,0]
    v_pk_fma_f32 v[102:103], v[34:35], v[70:71], v[102:103]
    v_cvt_pk_f16_f32 v12, v96, v100
    v_cvt_pk_f16_f32 v13, v97, v101
    v_cvt_pk_f16_f32 v14, v98, v102
    v_cvt_pk_f16_f32 v15, v99, v103
    s_nop 1
    v_mfma_f32_16x16x32_f16 v[40:43], v[56:59], v[12:15], 0
    v_mfma_f32_16x16x32_f16 v[44:47], v[60:63], v[12:15], 0
    v_pk_mul_f32 v[24:25], v[104:105], v[72:73] op_sel_hi:[1,0]
    v_pk_mul_f32 v[28:29], v[106:107], v[76:77] op_sel_hi:[1,0]
    v_pk_mul_f32 v[32:33], v[108:109], v[80:81] op_sel_hi:[1,0]
    v_pk_mul_f32 v[36:37], v[110:111], v[84:85] op_sel_hi:[1,0]
    v_pk_fma_f32 v[24:25], v[104:105], v[72:73], v[24:25] op_sel:[1,1,0] op_sel_hi:[0,1,1] neg_lo:[1,0,0]
    v_pk_fma_f32 v[28:29], v[106:107], v[76:77], v[28:29] op_sel:[1,1,0] op_sel_hi:[0,1,1] neg_lo:[1,0,0]
    v_pk_fma_f32 v[32:33], v[108:109], v[80:81], v[32:33] op_sel:[1,1,0] op_sel_hi:[0,1,1] neg_lo:[1,0,0]
    v_pk_fma_f32 v[36:37], v[110:111], v[84:85], v[36:37] op_sel:[1,1,0] op_sel_hi:[0,1,1] neg_lo:[1,0,0]
    v_pk_mul_f32 v[26:27], v[40:41], v[74:75] op_sel_hi:[1,0]
    v_pk_mul_f32 v[30:31], v[42:43], v[78:79] op_sel_hi:[1,0]
    v_pk_mul_f32 v[34:35], v[44:45], v[82:83] op_sel_hi:[1,0]
    v_pk_mul_f32 v[38:39], v[46:47], v[86:87] op_sel_hi:[1,0]
    v_pk_fma_f32 v[26:27], v[40:41], v[74:75], v[26:27] op_sel:[1,1,0] op_sel_hi:[0,1,1] neg_lo:[1,0,0]
    v_pk_fma_f32 v[30:31], v[42:43], v[78:79], v[30:31] op_sel:[1,1,0] op_sel_hi:[0,1,1] neg_lo:[1,0,0]
    v_pk_fma_f32 v[34:35], v[44:45], v[82:83], v[34:35] op_sel:[1,1,0] op_sel_hi:[0,1,1] neg_lo:[1,0,0]
    v_pk_fma_f32 v[38:39], v[46:47], v[86:87], v[38:39] op_sel:[1,1,0] op_sel_hi:[0,1,1] neg_lo:[1,0,0]
    ds_write_b128 v94, v[24:27] offset:0
    ds_write_b128 v94, v[28:31] offset:320
    ds_write_b128 v94, v[32:35] offset:2560
    ds_write_b128 v94, v[36:39] offset:2880
    s_branch K1_L5
K1_BG:
    s_waitcnt lgkmcnt(0)
    v_readfirstlane_b32 s8, v12
    s_nop 1
    s_min_u32 s0, s8, 255
    s_cmp_lg_u32 s3, 7
    s_cbranch_scc1 K1_PF
    v_min_u32 v48, 55, v1
    v_lshlrev_b32 v48, 5, v48
    s_and_b32 s62, s2, 7
    s_lshl_b32 s62, s62, 11
    s_add_u32 s62, s62, 200704
    s_branch K1_L5
K1_PF:
    s_mov_b32 s66, 0x21c000
    s_mov_b32 s67, 0x20000
    s_lshr_b32 s8, s2, 3
    s_and_b32 s9, s2, 7
    s_lshl_b32 s13, s9, 7
    s_cmp_eq_u32 s3, 6
    s_cbranch_scc1 PFW1_6
    s_mov_b32 s64, s26
    s_mov_b32 s65, s27
    s_movk_i32 s10, 3456
    s_mul_i32 s12, s8, 69120
    s_add_u32 s12, s12, s13
    v_mul_u32_u24 v8, 13, v1
    v_lshrrev_b32 v8, 8, v8
    v_mul_u32_u24 v9, 20, v8
    v_sub_u32 v9, v1, v9
    v_mul_u32_u24 v9, s10, v9
    v_lshl_add_u32 v9, v8, 10, v9
    s_mov_b32 exec_hi, 0x0fffffff
    buffer_load_dword v126, v9, s[64:67], s12 offen offset:0
    s_mov_b64 exec, -1
PFW1_0_0:
    s_branch PFW1_E
PFW1_6:
    s_cmp_ge_u32 s9, 3
    s_cbranch_scc1 PFW1_1_0
    s_mov_b32 s64, s26
    s_mov_b32 s65, s27
    s_movk_i32 s10, 3456
    s_mul_i32 s12, s8, 69120
    s_add_u32 s12, s12, s13
    v_mul_u32_u24 v9, s10, v1
    s_mov_b64 exec, 0xfffff
    buffer_load_dword v126, v9, s[64:67], s12 offen offset:3072
    s_mov_b64 exec, -1
PFW1_1_0:
    s_cmp_ge_u32 s9, 3
    s_cbranch_scc1 PFW1_1_1
    s_mov_b32 s64, s28
    s_mov_b32 s65, s29
    s_movk_i32 s10, 3456
    s_mul_i32 s12, s8, 69120
    s_add_u32 s12, s12, s13
    v_mul_u32_u24 v9, s10, v1
    s_mov_b64 exec, 0xfffff
    buffer_load_dword v126, v9, s[64:67], s12 offen offset:3072
    s_mov_b64 exec, -1
PFW1_1_1:
PFW1_E:
K1_L5:
    s_waitcnt lgkmcnt(0)
    s_barrier
    ds_read_b128 v[8:11], v95 offset:0
    ds_read_b128 v[12:15], v95 offset:16
    ds_read_b128 v[16:19], v95 offset:32
    ds_read_b128 v[20:23], v95 offset:48
    ds_read_b128 v[24:27], v95 offset:64
    v_mov_b32 v83, s1
    v_mov_b32 v87, s1
    s_waitcnt lgkmcnt(0)
    v_pk_fma_f32 v[28:29], v[18:19], v[114:115], v[8:9] op_sel_hi:[1,0,1]
    v_pk_fma_f32 v[30:31], v[22:23], v[114:115], v[12:13] op_sel_hi:[1,0,1]
    v_pk_fma_f32 v[32:33], v[26:27], v[114:115], v[16:17] op_sel_hi:[1,0,1]
    v_pk_fma_f32 v[34:35], v[10:11], v[114:115], v[20:21] op_sel_hi:[1,0,1]
    v_pk_fma_f32 v[36:37], v[14:15], v[114:115], v[24:25] op_sel_hi:[1,0,1]
    v_pk_add_f32 v[64:65], v[30:31], v[36:37]
    v_pk_add_f32 v[66:67], v[32:33], v[34:35]
    v_pk_add_f32 v[68:69], v[30:31], v[36:37] neg_lo:[0,1] neg_hi:[0,1]
    v_pk_add_f32 v[70:71], v[32:33], v[34:35] neg_lo:[0,1] neg_hi:[0,1]
    v_pk_fma_f32 v[72:73], v[64:65], s[70:71], v[28:29] op_sel_hi:[1,0,1]
    v_pk_fma_f32 v[74:75], v[64:65], s[70:71], v[28:29] op_sel:[0,1,0] op_sel_hi:[1,1,1]
    v_pk_add_f32 v[52:53], v[28:29], v[64:65]
    v_pk_fma_f32 v[72:73], v[66:67], s[70:71], v[72:73] op_sel:[0,1,0] op_sel_hi:[1,1,1]
    v_pk_fma_f32 v[74:75], v[66:67], s[70:71], v[74:75] op_sel_hi:[1,0,1]
    v_pk_add_f32 v[52:53], v[52:53], v[66:67]
    v_pk_mul_f32 v[64:65], v[68:69], s[72:73] op_sel_hi:[1,0]
    v_pk_mul_f32 v[66:67], v[68:69], s[72:73] op_sel:[0,1] op_sel_hi:[1,1]
    v_pk_fma_f32 v[64:65], v[70:71], s[72:73], v[64:65] op_sel:[0,1,0] op_sel_hi:[1,1,1]
    v_pk_fma_f32 v[66:67], v[70:71], s[72:73], v[66:67] op_sel_hi:[1,0,1] neg_lo:[1,0,0] neg_hi:[1,0,0]
    v_pk_add_f32 v[54:55], v[64:65], v[72:73] op_sel:[1,0] op_sel_hi:[0,1] neg_hi:[1,0]
    v_pk_add_f32 v[60:61], v[64:65], v[72:73] op_sel:[1,0] op_sel_hi:[0,1] neg_lo:[1,0]
    v_pk_add_f32 v[56:57], v[66:67], v[74:75] op_sel:[1,0] op_sel_hi:[0,1] neg_hi:[1,0]
    v_pk_add_f32 v[58:59], v[66:67], v[74:75] op_sel:[1,0] op_sel_hi:[0,1] neg_lo:[1,0]
    v_cvt_pk_f16_f32 v8, v52, v53
    v_cvt_pk_f16_f32 v9, v56, v57
    v_cvt_pk_f16_f32 v12, v60, v61
    v_cvt_pk_f16_f32 v13, v54, v55
    v_cvt_pk_f16_f32 v16, v58, v59
    v_perm_b32 v10, v83, v16, s61
    v_perm_b32 v14, v83, v16, s60
    s_mov_b32 vcc_lo, 0x33333333
    s_mov_b32 vcc_hi, 0x33333333
    v_cndmask_b32_dpp v80, v12, v8, vcc quad_perm:[2,3,0,1] row_mask:0xf bank_mask:0xf
    v_cndmask_b32_dpp v81, v13, v9, vcc quad_perm:[2,3,0,1] row_mask:0xf bank_mask:0xf
    v_cndmask_b32_dpp v82, v14, v10, vcc quad_perm:[2,3,0,1] row_mask:0xf bank_mask:0xf
    s_not_b64 vcc, vcc
    v_cndmask_b32_dpp v84, v8, v12, vcc quad_perm:[2,3,0,1] row_mask:0xf bank_mask:0xf
    v_cndmask_b32_dpp v85, v9, v13, vcc quad_perm:[2,3,0,1] row_mask:0xf bank_mask:0xf
    v_cndmask_b32_dpp v86, v10, v14, vcc quad_perm:[2,3,0,1] row_mask:0xf bank_mask:0xf
    s_cmp_lg_u32 s3, 7
    s_cbranch_scc1 K1_NFA
    buffer_load_dwordx4 v[40:43], v48, s[44:47], s62 offen
    buffer_load_dwordx4 v[44:47], v48, s[44:47], s62 offen offset:16
K1_NFA:
    buffer_store_dwordx4 v[80:83], v88, s[44:47], s14 offen sc1
    buffer_store_dwordx4 v[84:87], v88, s[44:47], s14 offen offset:512 sc1
    v_and_b32 v2, 15, v1
    v_lshrrev_b32 v3, 4, v1
    v_lshl_add_u32 v4, v3, 6, v2
    v_lshlrev_b32 v6, 4, v1
    v_mul_u32_u24 v7, 40, v4
    s_lshr_b32 s6, s4, 6
    s_and_b32 s7, s4, 63
    s_lshl_b32 s11, s4, 6
    s_add_u32 s11, s11, 1048576
    s_add_u32 s14, s11, 2097152
    v_lshrrev_b32 v5, 2, v0
    v_and_b32 v125, 3, v0
    v_lshlrev_b32 v3, 14, v5
    v_lshl_add_u32 v3, v125, 4, v3
    v_mul_u32_u24 v5, 40, v5
    v_and_b32 v8, 1, v0
    v_bfe_u32 v9, v0, 1, 1
    v_lshl_add_u32 v125, v8, 2, v5
    v_lshl_add_u32 v125, v9, 1, v125
    v_lshl_add_u32 v5, v8, 4, v5
    v_lshl_add_u32 v5, v9, 3, v5
    s_and_b32 s88, s1, 0xffff
    s_mul_i32 s88, s88, 0x10001
    s_mov_b32 s89, 0x07060302
    s_lshl_b32 s90, s1, 16
    s_cmp_eq_u32 s4, 0
    s_cselect_b32 s5, 6, 5
    s_cmp_ge_u32 s3, s5
    s_cbranch_scc1 K2_G
    s_cmp_eq_u32 s6, 0
    s_cbranch_scc1 K2_T0
    s_lshl_b32 s9, s3, 3
    s_add_u32 s62, s9, 4
    s_lshl_b32 s10, s3, 1
    s_add_u32 s13, s10, 1
    s_and_b32 s12, s3, 5
    s_or_b32 s12, s12, s7
    s_cmp_eq_u32 s12, 0
    s_cselect_b32 s63, 1, 0
    s_lshl_b32 s12, s3, 11
    s_add_u32 s12, s12, 66816
    s_branch K2_C
K2_T0:
    s_cmp_eq_u32 s4, 0
    s_mov_b32 s9, 0x79210
    s_cselect_b32 s9, 0x497210, s9
    s_mov_b32 s62, 0x83456
    s_cselect_b32 s62, 0x456380, s62
    s_lshl_b32 s12, s3, 2
    s_lshr_b32 s9, s9, s12
    s_lshr_b32 s62, s62, s12
    s_and_b32 s9, s9, 15
    s_and_b32 s62, s62, 15
    s_cmp_eq_u32 s9, s62
    s_cselect_b32 s63, 2, 0
    s_lshl_b32 s9, s9, 2
    s_lshl_b32 s62, s62, 2
    s_cmp_eq_u32 s3, 5
    s_mov_b32 s12, 66816
    s_cselect_b32 s12, 70912, s12
    ds_read_b128 v[64:67], v6 offset:50432
    ds_read_b128 v[68:71], v6 offset:51456
    s_mov_b32 s10, s3
    s_add_u32 s13, s3, 5
K2_C:
    s_lshl_b32 s10, s10, 10
    s_lshl_b32 s13, s13, 10
    s_add_u32 s10, s10, 56576
    s_add_u32 s13, s13, 56576
    v_add_u32 v72, s10, v6
    v_add_u32 v73, s13, v6
    v_lshl_add_u32 v74, v6, 1, s12
    ds_read_b128 v[40:43], v6 offset:44288
    ds_read_b128 v[44:47], v6 offset:45312
    ds_read_b128 v[48:51], v6 offset:46336
    ds_read_b128 v[52:55], v6 offset:47360
    ds_read_b128 v[56:59], v6 offset:48384
    ds_read_b128 v[60:63], v6 offset:49408
    v_add_u32 v76, s9, v7
    v_add_u32 v78, s62, v7
    v_add_u32 v77, 1280, v76
    v_add_u32 v79, 1280, v78
    s_branch K2_G2
K2_G:
    s_cmp_lg_u32 s3, 7
    s_cbranch_scc1 K2_G6
    s_mov_b32 s15, 65536
    s_mov_b32 s63, 0
    s_mov_b32 s97, 0
    s_mov_b64 s[68:69], -1
    s_waitcnt vmcnt(2)
    v_xor_b32 v8, s1, v41
    v_xor_b32 v9, s1, v43
    v_xor_b32 v10, s1, v45
    v_xor_b32 v11, s1, v47
    v_or3_b32 v8, v8, v9, v10
    v_or_b32 v8, v8, v11
    v_cmp_ne_u32 vcc, 0, v8
    s_cbranch_vccnz W7_LOOP
    buffer_load_dwordx4 v[112:115], v3, s[44:47], s11 offen sc1
    buffer_load_dwordx4 v[116:119], v3, s[44:47], s14 offen sc1
    s_branch W7_OK
W7_LOOP:
    s_cmp_lg_u32 s63, 0
    s_cbranch_scc1 W7_L1
    buffer_load_dwordx4 v[40:43], v48, s[44:47], s62 offen sc1
    buffer_load_dwordx4 v[44:47], v48, s[44:47], s62 offen offset:16 sc1
W7_L1:
    s_mov_b64 exec, s[68:69]
    buffer_load_dwordx4 v[112:115], v3, s[44:47], s11 offen sc1
    buffer_load_dwordx4 v[116:119], v3, s[44:47], s14 offen sc1
    s_mov_b64 exec, -1
    s_lshl_b32 s63, s63, 1
    s_min_u32 s63, s63, 2
    s_cmp_lg_u32 s63, 0
    s_cbranch_scc1 W7_W0
    s_waitcnt vmcnt(2)
W7_FACHK:
    v_xor_b32 v8, s1, v41
    v_xor_b32 v9, s1, v43
    v_xor_b32 v10, s1, v45
    v_xor_b32 v11, s1, v47
    v_or3_b32 v8, v8, v9, v10
    v_or_b32 v8, v8, v11
    v_cmp_ne_u32 vcc, 0, v8
    s_cbranch_vccnz W7_W0
W7_OK:
    s_mov_b32 s63, 1
    s_cmp_eq_u32 s6, 0
    s_cbranch_scc1 FA_T0
    s_mul_i32 s9, s6, 321
    s_add_u32 s9, s9, s7
    s_sub_u32 s10, 3208, s9
    s_lshl_b32 s9, s9, 10
    s_lshl_b32 s10, s10, 10
    s_mov_b32 m0, 56576
    s_add_u32 s8, s9, 9437184
    buffer_load_dwordx4 v6, s[44:47], s8 offen lds
    s_mov_b32 m0, 57600
    s_add_u32 s8, s9, 9568256
    buffer_load_dwordx4 v6, s[44:47], s8 offen lds
    s_mov_b32 m0, 58624
    s_add_u32 s8, s9, 9699328
    buffer_load_dwordx4 v6, s[44:47], s8 offen lds
    s_mov_b32 m0, 59648
    s_add_u32 s8, s10, 9043968
    buffer_load_dwordx4 v6, s[44:47], s8 offen lds
    s_mov_b32 m0, 60672
    s_add_u32 s8, s10, 9109504
    buffer_load_dwordx4 v6, s[44:47], s8 offen lds
    s_mov_b32 m0, 61696
    s_add_u32 s8, s10, 8978432
    buffer_load_dwordx4 v6, s[44:47], s8 offen lds
    s_mov_b32 m0, 62720
    s_add_u32 s8, s10, 8847360
    buffer_load_dwordx4 v6, s[44:47], s8 offen lds
    s_mov_b32 m0, 63744
    s_add_u32 s8, s9, 9502720
    buffer_load_dwordx4 v6, s[44:47], s8 offen lds
    s_mov_b32 m0, 64768
    s_add_u32 s8, s10, 8912896
    buffer_load_dwordx4 v6, s[44:47], s8 offen lds
    s_mov_b32 m0, 65792
    s_add_u32 s8, s9, 9633792
    buffer_load_dwordx4 v6, s[44:47], s8 offen lds
    s_branch FA_T1
FA_T0:
    s_lshl_b32 s9, s7, 10
    s_sub_u32 s10, 262144, s9
    s_sub_u32 s12, 131072, s9
    s_cmp_eq_u32 s7, 0
    s_cselect_b32 s10, 65536, s10
    s_cselect_b32 s12, 196608, s12
    s_mov_b32 m0, 56576
    s_add_u32 s8, s9, 9437184
    buffer_load_dwordx4 v6, s[44:47], s8 offen lds
    s_mov_b32 m0, 57600
    s_add_u32 s8, s9, 9568256
    buffer_load_dwordx4 v6, s[44:47], s8 offen lds
    s_mov_b32 m0, 58624
    s_add_u32 s8, s9, 9699328
    buffer_load_dwordx4 v6, s[44:47], s8 offen lds
    s_mov_b32 m0, 59648
    s_add_u32 s8, s10, 9437184
    buffer_load_dwordx4 v6, s[44:47], s8 offen lds
    s_mov_b32 m0, 60672
    s_add_u32 s8, s12, 9437184
    buffer_load_dwordx4 v6, s[44:47], s8 offen lds
    s_mov_b32 m0, 61696
    s_add_u32 s8, s9, 10752000
    buffer_load_dwordx4 v6, s[44:47], s8 offen lds
    s_mov_b32 m0, 62720
    s_add_u32 s8, s9, 10883072
    buffer_load_dwordx4 v6, s[44:47], s8 offen lds
    s_mov_b32 m0, 63744
    s_add_u32 s8, s9, 11014144
    buffer_load_dwordx4 v6, s[44:47], s8 offen lds
    s_mov_b32 m0, 64768
    s_add_u32 s8, s10, 10752000
    buffer_load_dwordx4 v6, s[44:47], s8 offen lds
    s_mov_b32 m0, 65792
    s_add_u32 s8, s12, 10752000
    buffer_load_dwordx4 v6, s[44:47], s8 offen lds
FA_T1:
    v_max3_u32 v40, v40, v42, v44
    v_max_u32 v40, v40, v46
    s_nop 1
    v_max_u32_dpp v40, v40, v40 row_ror:8 row_mask:0xf bank_mask:0xf
    s_nop 1
    v_max_u32_dpp v40, v40, v40 row_ror:4 row_mask:0xf bank_mask:0xf
    s_nop 1
    v_max_u32_dpp v40, v40, v40 row_ror:2 row_mask:0xf bank_mask:0xf
    s_nop 1
    v_max_u32_dpp v40, v40, v40 row_ror:1 row_mask:0xf bank_mask:0xf
    s_nop 1
    v_max_u32_dpp v40, v40, v40 row_bcast:15 row_mask:0xa bank_mask:0xf
    s_nop 1
    v_max_u32_dpp v40, v40, v40 row_bcast:31 row_mask:0xc bank_mask:0xf
    v_lshrrev_b32 v40, 7, v40
    v_min_u32 v40, 251, v40
    v_add_u32 v56, 1, v40
    s_cmp_lg_u32 s7, 0
    s_cbranch_scc1 W7_W10
    s_lshl_b32 s8, s6, 11
    s_add_u32 s8, s8, 131072
    s_mov_b32 m0, 66816
    s_add_u32 s9, s8, 0
    buffer_load_dwordx4 v6, s[44:47], s9 offen lds
    s_mov_b32 m0, 67840
    s_add_u32 s9, s8, 1024
    buffer_load_dwordx4 v6, s[44:47], s9 offen lds
    s_mov_b32 m0, 68864
    s_add_u32 s9, s8, 8192
    buffer_load_dwordx4 v6, s[44:47], s9 offen lds
    s_mov_b32 m0, 69888
    s_add_u32 s9, s8, 9216
    buffer_load_dwordx4 v6, s[44:47], s9 offen lds
    s_mov_b32 m0, 70912
    s_add_u32 s9, s8, 10240
    buffer_load_dwordx4 v6, s[44:47], s9 offen lds
    s_mov_b32 m0, 71936
    s_add_u32 s9, s8, 11264
    buffer_load_dwordx4 v6, s[44:47], s9 offen lds
    s_mov_b32 m0, 72960
    s_add_u32 s9, s8, 18432
    buffer_load_dwordx4 v6, s[44:47], s9 offen lds
    s_mov_b32 m0, 73984
    s_add_u32 s9, s8, 19456
    buffer_load_dwordx4 v6, s[44:47], s9 offen lds
    s_cmp_eq_u32 s97, 2
    s_cbranch_scc1 W7_P2
    s_waitcnt vmcnt(18)
    s_branch W7_NEXT
W7_W10:
    s_cmp_eq_u32 s97, 2
    s_cbranch_scc1 W7_P2
    s_waitcnt vmcnt(10)
    s_branch W7_NEXT
W7_P2:
    s_mov_b32 s97, 0
    s_branch W7_L1
W7_W0:
    s_waitcnt vmcnt(0)
W7_NEXT:
    s_cmp_eq_u32 s97, 1
    s_cbranch_scc1 W7_POST
    s_mov_b64 exec, s[68:69]
    v_perm_b32 v8, v118, v114, s89
    v_xor_b32 v9, s1, v115
    v_xor_b32 v10, s1, v119
    v_xor_b32 v8, s88, v8
    v_or3_b32 v8, v8, v9, v10
    v_cmp_ne_u32 vcc, 0, v8
    s_nop 1
    s_mov_b64 s[68:69], vcc
    s_mov_b64 exec, -1
    s_sub_u32 s15, s15, 1
    s_cbranch_scc1 W7_OUT
    s_cmp_lg_u64 s[68:69], 0
    s_cbranch_scc1 W7_LOOP
W7_OUT:
    s_cmp_lg_u32 s63, 2
    s_cbranch_scc1 E1_DONE
    v_mov_b32 v8, 0
    s_mov_b32 exec_lo, 0
    s_mov_b32 exec_hi, 0x80000000
    ds_write_b32 v8, v56 offset:36036
    s_mov_b64 exec, -1
    s_branch E1_DONE
K2_G6:
K2_G2:
    s_sleep 15
E1_NS:
    s_mov_b32 s15, 65536
    buffer_load_dwordx4 v[112:115], v3, s[44:47], s11 offen
    buffer_load_dwordx4 v[116:119], v3, s[44:47], s14 offen
    s_waitcnt vmcnt(0)
    s_branch E1_CHK
E1_LOOP:
    buffer_load_dwordx4 v[112:115], v3, s[44:47], s11 offen sc1
    buffer_load_dwordx4 v[116:119], v3, s[44:47], s14 offen sc1
    s_waitcnt vmcnt(0)
E1_CHK:
    v_perm_b32 v8, v118, v114, s89
    v_xor_b32 v9, s1, v115
    v_xor_b32 v10, s1, v119
    v_xor_b32 v8, s88, v8
    v_or3_b32 v8, v8, v9, v10
    v_cmp_ne_u32 vcc, 0, v8
    s_sub_u32 s15, s15, 1
    s_cbranch_scc1 E1_DONE
    s_cbranch_vccz E1_DONE
    s_mov_b64 exec, vcc
    s_branch E1_LOOP
E1_DONE:
    s_mov_b64 exec, -1
    ds_write_b64 v5, v[112:113] offset:0
    ds_write_b16 v125, v114 offset:32
    ds_write_b64 v5, v[116:117] offset:5120
    ds_write_b16 v125, v118 offset:5152
    s_cmp_lt_u32 s3, 6
    s_cbranch_scc1 K2_PF6
    v_lshlrev_b32 v54, 5, v1
    v_lshlrev_b32 v55, 3, v1
    v_lshlrev_b32 v10, 2, v1
    s_cmp_eq_u32 s3, 6
    s_mov_b32 s95, 264704
    s_cselect_b32 s95, 262144, s95
    s_mov_b32 s96, 267264
    s_cselect_b32 s96, 269824, s96
    buffer_load_dwordx4 v[64:67], v54, s[44:47], s95 offen sc1
    buffer_load_dwordx4 v[68:71], v54, s[44:47], s95 offen offset:16 sc1
    buffer_load_dwordx2 v[72:73], v55, s[44:47], s95 offen offset:2048 sc1
    buffer_load_dwordx4 v[74:77], v54, s[44:47], s96 offen sc1
    buffer_load_dwordx4 v[78:81], v54, s[44:47], s96 offen offset:16 sc1
    buffer_load_dwordx2 v[82:83], v55, s[44:47], s96 offen offset:2048 sc1
    s_cbranch_scc1 K2_PF6
    s_mov_b32 s64, s24
    s_mov_b32 s65, s25
    s_mov_b32 s66, 0x500
    s_mov_b32 s67, 0x20000
    buffer_load_dwordx4 v[88:91], v6, s[64:67], 0 offen offset:0
    buffer_load_dword v93, v10, s[64:67], 0 offen offset:1024
K2_PF6:
    v_mov_b32 v4, 0
    s_waitcnt lgkmcnt(0)
    s_barrier
    s_cmp_ge_u32 s3, s5
    s_cbranch_scc1 K2_BG
    ds_read2_b32 v[8:9], v76 offset0:0 offset1:160
    ds_read2_b32 v[10:11], v77 offset0:0 offset1:160
    ds_read2_b32 v[12:13], v78 offset0:0 offset1:160
    ds_read2_b32 v[14:15], v79 offset0:0 offset1:160
    ds_read_b32 v75, v4 offset:36036
    ds_read_b128 v[16:19], v72
    ds_read_b128 v[20:23], v73
    s_waitcnt lgkmcnt(3)
    s_cmp_lg_u32 s6, 0
    s_cbranch_scc1 K2_MAIN
    v_fma_mix_f32 v80, v8, 1.0, v12 op_sel_hi:[1,0,1]
    v_fma_mix_f32 v84, v8, 1.0, -v12 op_sel:[1,0,1] op_sel_hi:[1,0,1]
    v_fma_mix_f32 v88, v8, 1.0, v12 op_sel:[1,0,1] op_sel_hi:[1,0,1]
    v_fma_mix_f32 v92, v8, -1.0, v12 op_sel_hi:[1,0,1]
    v_fma_mix_f32 v81, v9, 1.0, v13 op_sel_hi:[1,0,1]
    v_fma_mix_f32 v85, v9, 1.0, -v13 op_sel:[1,0,1] op_sel_hi:[1,0,1]
    v_fma_mix_f32 v89, v9, 1.0, v13 op_sel:[1,0,1] op_sel_hi:[1,0,1]
    v_fma_mix_f32 v93, v9, -1.0, v13 op_sel_hi:[1,0,1]
    v_fma_mix_f32 v82, v10, 1.0, v14 op_sel_hi:[1,0,1]
    v_fma_mix_f32 v86, v10, 1.0, -v14 op_sel:[1,0,1] op_sel_hi:[1,0,1]
    v_fma_mix_f32 v90, v10, 1.0, v14 op_sel:[1,0,1] op_sel_hi:[1,0,1]
    v_fma_mix_f32 v94, v10, -1.0, v14 op_sel_hi:[1,0,1]
    v_fma_mix_f32 v83, v11, 1.0, v15 op_sel_hi:[1,0,1]
    v_fma_mix_f32 v87, v11, 1.0, -v15 op_sel:[1,0,1] op_sel_hi:[1,0,1]
    v_fma_mix_f32 v91, v11, 1.0, v15 op_sel:[1,0,1] op_sel_hi:[1,0,1]
    v_fma_mix_f32 v95, v11, -1.0, v15 op_sel_hi:[1,0,1]
    v_pk_mul_f32 v[96:97], v[88:89], v[64:65]
    v_pk_mul_f32 v[100:101], v[92:93], v[64:65]
    v_pk_mul_f32 v[98:99], v[90:91], v[66:67]
    v_pk_mul_f32 v[102:103], v[94:95], v[66:67]
    v_pk_fma_f32 v[96:97], v[92:93], v[68:69], v[96:97] neg_lo:[1,0,0] neg_hi:[1,0,0]
    v_pk_fma_f32 v[100:101], v[88:89], v[68:69], v[100:101]
    v_pk_fma_f32 v[98:99], v[94:95], v[70:71], v[98:99] neg_lo:[1,0,0] neg_hi:[1,0,0]
    v_pk_fma_f32 v[102:103], v[90:91], v[70:71], v[102:103]
    v_cvt_pk_f16_f32 v8, v80, v84
    v_cvt_pk_f16_f32 v12, v96, v100
    v_cvt_pk_f16_f32 v9, v81, v85
    v_cvt_pk_f16_f32 v13, v97, v101
    v_cvt_pk_f16_f32 v10, v82, v86
    v_cvt_pk_f16_f32 v14, v98, v102
    v_cvt_pk_f16_f32 v11, v83, v87
    v_cvt_pk_f16_f32 v15, v99, v103
K2_MAIN:
    s_nop 1
    v_mfma_f32_16x16x32_f16 v[80:83], v[8:11], v[40:43], 0
    v_mfma_f32_16x16x32_f16 v[84:87], v[8:11], v[44:47], 0
    v_mfma_f32_16x16x32_f16 v[88:91], v[12:15], v[40:43], 0
    v_mfma_f32_16x16x32_f16 v[92:95], v[12:15], v[44:47], 0
    s_waitcnt lgkmcnt(0)
    v_readfirstlane_b32 s14, v75
    s_nop 1
    s_cmp_eq_u32 s14, 0
    s_cbranch_scc1 K2_LATE
    v_lshlrev_b32 v32, 16, v20
    v_and_b32 v36, 0xffff0000, v20
    v_lshlrev_b32 v33, 16, v21
    v_and_b32 v37, 0xffff0000, v21
    v_lshlrev_b32 v34, 16, v22
    v_and_b32 v38, 0xffff0000, v22
    v_lshlrev_b32 v35, 16, v23
    v_and_b32 v39, 0xffff0000, v23
    v_lshlrev_b32 v24, 16, v16
    v_and_b32 v28, 0xffff0000, v16
    v_lshlrev_b32 v25, 16, v17
    v_and_b32 v29, 0xffff0000, v17
    v_lshlrev_b32 v26, 16, v18
    v_and_b32 v30, 0xffff0000, v18
    v_lshlrev_b32 v27, 16, v19
    v_and_b32 v31, 0xffff0000, v19
    s_cmp_eq_u32 s63, 0
    s_cbranch_scc1 K2_NOSP
    ds_read_b128 v[24:27], v74 offset:0
    ds_read_b128 v[28:31], v74 offset:16
    s_cmp_eq_u32 s63, 1
    s_cbranch_scc1 K2_NOSP
    ds_read_b128 v[32:35], v74 offset:2048
    ds_read_b128 v[36:39], v74 offset:2064
K2_NOSP:
    s_cmp_eq_u32 s6, 0
    s_cselect_b32 s12, 1, 0
    s_add_u32 s12, s12, s14
    s_sub_u32 s12, 253, s12
    s_max_i32 s12, s12, 1
    s_lshl_b32 s12, s12, 23
    v_pk_mul_f32 v[96:97], v[80:81], v[56:57]
    v_pk_mul_f32 v[100:101], v[84:85], v[56:57]
    v_pk_mul_f32 v[98:99], v[82:83], v[58:59]
    v_pk_mul_f32 v[102:103], v[86:87], v[58:59]
    v_pk_fma_f32 v[96:97], v[84:85], v[60:61], v[96:97] neg_lo:[1,0,0] neg_hi:[1,0,0]
    v_pk_fma_f32 v[100:101], v[80:81], v[60:61], v[100:101]
    v_pk_fma_f32 v[98:99], v[86:87], v[62:63], v[98:99] neg_lo:[1,0,0] neg_hi:[1,0,0]
    v_pk_fma_f32 v[102:103], v[82:83], v[62:63], v[102:103]
    v_cvt_pk_f16_f32 v8, v96, v100
    v_cvt_pk_f16_f32 v9, v97, v101
    v_cvt_pk_f16_f32 v10, v98, v102
    v_cvt_pk_f16_f32 v11, v99, v103
    s_nop 1
    v_mfma_f32_16x16x32_f16 v[80:83], v[40:43], v[8:11], 0
    v_mfma_f32_16x16x32_f16 v[84:87], v[44:47], v[8:11], 0
    v_pk_mul_f32 v[104:105], v[88:89], v[56:57]
    v_pk_mul_f32 v[108:109], v[92:93], v[56:57]
    v_pk_mul_f32 v[106:107], v[90:91], v[58:59]
    v_pk_mul_f32 v[110:111], v[94:95], v[58:59]
    v_pk_fma_f32 v[104:105], v[92:93], v[60:61], v[104:105] neg_lo:[1,0,0] neg_hi:[1,0,0]
    v_pk_fma_f32 v[108:109], v[88:89], v[60:61], v[108:109]
    v_pk_fma_f32 v[106:107], v[94:95], v[62:63], v[106:107] neg_lo:[1,0,0] neg_hi:[1,0,0]
    v_pk_fma_f32 v[110:111], v[90:91], v[62:63], v[110:111]
    v_cvt_pk_f16_f32 v12, v104, v108
    v_cvt_pk_f16_f32 v13, v105, v109
    v_cvt_pk_f16_f32 v14, v106, v110
    v_cvt_pk_f16_f32 v15, v107, v111
    s_nop 1
    v_mfma_f32_16x16x32_f16 v[88:91], v[40:43], v[12:15], 0
    v_mfma_f32_16x16x32_f16 v[92:95], v[44:47], v[12:15], 0
K2_J:
    s_waitcnt lgkmcnt(0)
    v_pk_mul_f32 v[24:25], v[24:25], s[12:13] op_sel_hi:[1,0]
    v_pk_mul_f32 v[26:27], v[26:27], s[12:13] op_sel_hi:[1,0]
    v_pk_mul_f32 v[28:29], v[28:29], s[12:13] op_sel_hi:[1,0]
    v_pk_mul_f32 v[30:31], v[30:31], s[12:13] op_sel_hi:[1,0]
    v_pk_mul_f32 v[32:33], v[32:33], s[12:13] op_sel_hi:[1,0]
    v_pk_mul_f32 v[34:35], v[34:35], s[12:13] op_sel_hi:[1,0]
    v_pk_mul_f32 v[36:37], v[36:37], s[12:13] op_sel_hi:[1,0]
    v_pk_mul_f32 v[38:39], v[38:39], s[12:13] op_sel_hi:[1,0]
    v_pk_mul_f32 v[96:97], v[80:81], v[24:25]
    v_pk_mul_f32 v[100:101], v[84:85], v[24:25]
    v_pk_mul_f32 v[98:99], v[82:83], v[26:27]
    v_pk_mul_f32 v[102:103], v[86:87], v[26:27]
    v_pk_fma_f32 v[96:97], v[84:85], v[28:29], v[96:97] neg_lo:[1,0,0] neg_hi:[1,0,0]
    v_pk_fma_f32 v[100:101], v[80:81], v[28:29], v[100:101]
    v_pk_fma_f32 v[98:99], v[86:87], v[30:31], v[98:99] neg_lo:[1,0,0] neg_hi:[1,0,0]
    v_pk_fma_f32 v[102:103], v[82:83], v[30:31], v[102:103]
    v_cvt_pk_f16_f32 v8, v96, v100
    v_cvt_pk_f16_f32 v9, v97, v101
    v_cvt_pk_f16_f32 v10, v98, v102
    v_cvt_pk_f16_f32 v11, v99, v103
    s_nop 1
    v_mfma_f32_16x16x32_f16 v[80:83], v[8:11], v[48:51], 0
    v_mfma_f32_16x16x32_f16 v[84:87], v[8:11], v[52:55], 0
    v_pk_mul_f32 v[104:105], v[88:89], v[32:33]
    v_pk_mul_f32 v[108:109], v[92:93], v[32:33]
    v_pk_mul_f32 v[106:107], v[90:91], v[34:35]
    v_pk_mul_f32 v[110:111], v[94:95], v[34:35]
    v_pk_fma_f32 v[104:105], v[92:93], v[36:37], v[104:105] neg_lo:[1,0,0] neg_hi:[1,0,0]
    v_pk_fma_f32 v[108:109], v[88:89], v[36:37], v[108:109]
    v_pk_fma_f32 v[106:107], v[94:95], v[38:39], v[106:107] neg_lo:[1,0,0] neg_hi:[1,0,0]
    v_pk_fma_f32 v[110:111], v[90:91], v[38:39], v[110:111]
    v_cvt_pk_f16_f32 v12, v104, v108
    v_cvt_pk_f16_f32 v13, v105, v109
    v_cvt_pk_f16_f32 v14, v106, v110
    v_cvt_pk_f16_f32 v15, v107, v111
    s_nop 1
    v_mfma_f32_16x16x32_f16 v[88:91], v[12:15], v[48:51], 0
    v_mfma_f32_16x16x32_f16 v[92:95], v[12:15], v[52:55], 0
    v_pk_mul_f32 v[96:97], v[80:81], v[56:57]
    v_pk_mul_f32 v[100:101], v[84:85], v[56:57]
    v_pk_mul_f32 v[98:99], v[82:83], v[58:59]
    v_pk_mul_f32 v[102:103], v[86:87], v[58:59]
    v_pk_fma_f32 v[96:97], v[84:85], v[60:61], v[96:97]
    v_pk_fma_f32 v[100:101], v[80:81], v[60:61], v[100:101] neg_lo:[1,0,0] neg_hi:[1,0,0]
    v_pk_fma_f32 v[98:99], v[86:87], v[62:63], v[98:99]
    v_pk_fma_f32 v[102:103], v[82:83], v[62:63], v[102:103] neg_lo:[1,0,0] neg_hi:[1,0,0]
    v_cvt_pk_f16_f32 v8, v96, v100
    v_cvt_pk_f16_f32 v9, v97, v101
    v_cvt_pk_f16_f32 v10, v98, v102
    v_cvt_pk_f16_f32 v11, v99, v103
    s_nop 1
    v_mfma_f32_16x16x32_f16 v[80:83], v[48:51], v[8:11], 0
    v_mfma_f32_16x16x32_f16 v[84:87], v[52:55], v[8:11], 0
    v_pk_mul_f32 v[104:105], v[88:89], v[56:57]
    v_pk_mul_f32 v[108:109], v[92:93], v[56:57]
    v_pk_mul_f32 v[106:107], v[90:91], v[58:59]
    v_pk_mul_f32 v[110:111], v[94:95], v[58:59]
    v_pk_fma_f32 v[104:105], v[92:93], v[60:61], v[104:105]
    v_pk_fma_f32 v[108:109], v[88:89], v[60:61], v[108:109] neg_lo:[1,0,0] neg_hi:[1,0,0]
    v_pk_fma_f32 v[106:107], v[94:95], v[62:63], v[106:107]
    v_pk_fma_f32 v[110:111], v[90:91], v[62:63], v[110:111] neg_lo:[1,0,0] neg_hi:[1,0,0]
    v_cvt_pk_f16_f32 v12, v104, v108
    v_cvt_pk_f16_f32 v13, v105, v109
    v_cvt_pk_f16_f32 v14, v106, v110
    v_cvt_pk_f16_f32 v15, v107, v111
    s_nop 1
    v_mfma_f32_16x16x32_f16 v[88:91], v[48:51], v[12:15], 0
    v_mfma_f32_16x16x32_f16 v[92:95], v[52:55], v[12:15], 0
    s_cmp_eq_u32 s6, 0
    s_cbranch_scc1 K2_T0POST
    s_nop 7
    v_cvt_pk_f16_f32 v8, v80, v84
    v_cvt_pk_f16_f32 v12, v88, v92
    v_cvt_pk_f16_f32 v9, v81, v85
    v_cvt_pk_f16_f32 v13, v89, v93
    v_cvt_pk_f16_f32 v10, v82, v86
    v_cvt_pk_f16_f32 v14, v90, v94
    v_cvt_pk_f16_f32 v11, v83, v87
    v_cvt_pk_f16_f32 v15, v91, v95
    s_branch K2_ST
K2_LATE:
    s_nop 7
    v_pk_mul_f32 v[96:97], v[80:81], v[56:57]
    v_pk_mul_f32 v[100:101], v[84:85], v[56:57]
    v_pk_mul_f32 v[98:99], v[82:83], v[58:59]
    v_pk_mul_f32 v[102:103], v[86:87], v[58:59]
    v_pk_fma_f32 v[96:97], v[84:85], v[60:61], v[96:97] neg_lo:[1,0,0] neg_hi:[1,0,0]
    v_pk_fma_f32 v[100:101], v[80:81], v[60:61], v[100:101]
    v_pk_fma_f32 v[98:99], v[86:87], v[62:63], v[98:99] neg_lo:[1,0,0] neg_hi:[1,0,0]
    v_pk_fma_f32 v[102:103], v[82:83], v[62:63], v[102:103]
    v_cvt_pk_f16_f32 v8, v96, v100
    v_cvt_pk_f16_f32 v9, v97, v101
    v_cvt_pk_f16_f32 v10, v98, v102
    v_cvt_pk_f16_f32 v11, v99, v103
    s_nop 1
    v_mfma_f32_16x16x32_f16 v[80:83], v[40:43], v[8:11], 0
    v_mfma_f32_16x16x32_f16 v[84:87], v[44:47], v[8:11], 0
    v_pk_mul_f32 v[104:105], v[88:89], v[56:57]
    v_pk_mul_f32 v[108:109], v[92:93], v[56:57]
    v_pk_mul_f32 v[106:107], v[90:91], v[58:59]
    v_pk_mul_f32 v[110:111], v[94:95], v[58:59]
    v_pk_fma_f32 v[104:105], v[92:93], v[60:61], v[104:105] neg_lo:[1,0,0] neg_hi:[1,0,0]
    v_pk_fma_f32 v[108:109], v[88:89], v[60:61], v[108:109]
    v_pk_fma_f32 v[106:107], v[94:95], v[62:63], v[106:107] neg_lo:[1,0,0] neg_hi:[1,0,0]
    v_pk_fma_f32 v[110:111], v[90:91], v[62:63], v[110:111]
    v_cvt_pk_f16_f32 v12, v104, v108
    v_cvt_pk_f16_f32 v13, v105, v109
    v_cvt_pk_f16_f32 v14, v106, v110
    v_cvt_pk_f16_f32 v15, v107, v111
    s_nop 1
    v_mfma_f32_16x16x32_f16 v[88:91], v[40:43], v[12:15], 0
    v_mfma_f32_16x16x32_f16 v[92:95], v[44:47], v[12:15], 0
    s_mov_b32 s15, 1048576
K2_SPIN:
    ds_read_b32 v75, v4 offset:36036
    ds_read_b128 v[16:19], v72
    ds_read_b128 v[20:23], v73
    s_waitcnt lgkmcnt(0)
    v_readfirstlane_b32 s14, v75
    s_sub_u32 s15, s15, 1
    s_cbranch_scc1 K2_SPE
    s_cmp_eq_u32 s14, 0
    s_cbranch_scc1 K2_SPIN
K2_SPE:
    v_lshlrev_b32 v32, 16, v20
    v_and_b32 v36, 0xffff0000, v20
    v_lshlrev_b32 v33, 16, v21
    v_and_b32 v37, 0xffff0000, v21
    v_lshlrev_b32 v34, 16, v22
    v_and_b32 v38, 0xffff0000, v22
    v_lshlrev_b32 v35, 16, v23
    v_and_b32 v39, 0xffff0000, v23
    v_lshlrev_b32 v24, 16, v16
    v_and_b32 v28, 0xffff0000, v16
    v_lshlrev_b32 v25, 16, v17
    v_and_b32 v29, 0xffff0000, v17
    v_lshlrev_b32 v26, 16, v18
    v_and_b32 v30, 0xffff0000, v18
    v_lshlrev_b32 v27, 16, v19
    v_and_b32 v31, 0xffff0000, v19
    s_cmp_eq_u32 s63, 0
    s_cbranch_scc1 K2_NOSPl
    ds_read_b128 v[24:27], v74 offset:0
    ds_read_b128 v[28:31], v74 offset:16
    s_cmp_eq_u32 s63, 1
    s_cbranch_scc1 K2_NOSPl
    ds_read_b128 v[32:35], v74 offset:2048
    ds_read_b128 v[36:39], v74 offset:2064
K2_NOSPl:
    s_cmp_eq_u32 s6, 0
    s_cselect_b32 s12, 1, 0
    s_add_u32 s12, s12, s14
    s_sub_u32 s12, 253, s12
    s_max_i32 s12, s12, 1
    s_lshl_b32 s12, s12, 23
    s_branch K2_J
K2_T0POST:
    s_nop 7
    v_pk_mul_f32 v[96:97], v[88:89], v[64:65]
    v_pk_mul_f32 v[100:101], v[92:93], v[64:65]
    v_pk_mul_f32 v[98:99], v[90:91], v[66:67]
    v_pk_mul_f32 v[102:103], v[94:95], v[66:67]
    v_pk_fma_f32 v[96:97], v[92:93], v[68:69], v[96:97]
    v_pk_fma_f32 v[100:101], v[88:89], v[68:69], v[100:101] neg_lo:[1,0,0] neg_hi:[1,0,0]
    v_pk_fma_f32 v[98:99], v[94:95], v[70:71], v[98:99]
    v_pk_fma_f32 v[102:103], v[90:91], v[70:71], v[102:103] neg_lo:[1,0,0] neg_hi:[1,0,0]
    v_pk_add_f32 v[16:17], v[80:81], v[100:101] neg_lo:[0,1] neg_hi:[0,1]
    v_pk_add_f32 v[20:21], v[84:85], v[96:97]
    v_pk_add_f32 v[24:25], v[80:81], v[100:101]
    v_pk_add_f32 v[28:29], v[96:97], v[84:85] neg_lo:[0,1] neg_hi:[0,1]
    v_pk_add_f32 v[18:19], v[82:83], v[102:103] neg_lo:[0,1] neg_hi:[0,1]
    v_pk_add_f32 v[22:23], v[86:87], v[98:99]
    v_pk_add_f32 v[26:27], v[82:83], v[102:103]
    v_pk_add_f32 v[30:31], v[98:99], v[86:87] neg_lo:[0,1] neg_hi:[0,1]
    v_cvt_pk_f16_f32 v8, v16, v20
    v_cvt_pk_f16_f32 v12, v24, v28
    v_cvt_pk_f16_f32 v9, v17, v21
    v_cvt_pk_f16_f32 v13, v25, v29
    v_cvt_pk_f16_f32 v10, v18, v22
    v_cvt_pk_f16_f32 v14, v26, v30
    v_cvt_pk_f16_f32 v11, v19, v23
    v_cvt_pk_f16_f32 v15, v27, v31
K2_ST:
    ds_write2_b32 v78, v12, v13 offset0:0 offset1:160
    ds_write2_b32 v79, v14, v15 offset0:0 offset1:160
    ds_write2_b32 v76, v8, v9 offset0:0 offset1:160
    ds_write2_b32 v77, v10, v11 offset0:0 offset1:160
K2_BG:
    s_cmp_lg_u32 s3, 7
    s_cbranch_scc1 W7_END
    s_cmp_eq_u32 s63, 2
    s_cbranch_scc1 W7_END
    s_mov_b32 s97, 1
    s_waitcnt vmcnt(8)
    s_cmp_eq_u32 s63, 1
    s_cbranch_scc1 W7_FL
W7_POST:
    s_cmp_eq_u32 s63, 1
    s_cbranch_scc1 W7_FW
    s_sub_u32 s15, s15, 1
    s_cbranch_scc1 W7_FW
    buffer_load_dwordx4 v[40:43], v48, s[44:47], s62 offen sc1
    buffer_load_dwordx4 v[44:47], v48, s[44:47], s62 offen offset:16 sc1
    s_waitcnt vmcnt(0)
    s_branch W7_FACHK
W7_FW:
    s_waitcnt vmcnt(0)
W7_FL:
    v_mov_b32 v8, 0
    s_mov_b32 exec_lo, 0
    s_mov_b32 exec_hi, 0x80000000
    ds_write_b32 v8, v56 offset:36036
    s_mov_b64 exec, -1
W7_END:
    s_sub_u32 s8, s3, 5
    s_cmp_ge_u32 s8, 2
    s_cbranch_scc1 K2_NPF
    s_mov_b32 s66, 0x21c000
    s_mov_b32 s67, 0x20000
    s_lshr_b32 s8, s2, 3
    s_and_b32 s9, s2, 7
    s_lshl_b32 s13, s9, 7
    s_cmp_eq_u32 s3, 6
    s_cbranch_scc1 PFW2_6
    s_mov_b32 s64, s28
    s_mov_b32 s65, s29
    s_movk_i32 s10, 3456
    s_mul_i32 s12, s8, 69120
    s_add_u32 s12, s12, s13
    v_mul_u32_u24 v8, 13, v1
    v_lshrrev_b32 v8, 8, v8
    v_mul_u32_u24 v9, 20, v8
    v_sub_u32 v9, v1, v9
    v_mul_u32_u24 v9, s10, v9
    v_lshl_add_u32 v9, v8, 10, v9
    s_mov_b32 exec_hi, 0x0fffffff
    buffer_load_dword v126, v9, s[64:67], s12 offen offset:0
    s_mov_b64 exec, -1
PFW2_0_0:
    s_branch PFW2_E
PFW2_6:
PFW2_E:
K2_NPF:
    s_cmp_lt_u32 s3, 6
    s_cbranch_scc1 K2_OUT
    s_mov_b32 s94, 0
    s_cmp_lg_u32 s3, 6
    s_cbranch_scc1 K2_PBE
    s_mov_b32 s15, 1048576
K2_SP6:
    ds_read_b32 v84, v4 offset:36036
    s_waitcnt lgkmcnt(0)
    v_readfirstlane_b32 s7, v84
    s_sub_u32 s15, s15, 1
    s_cbranch_scc1 K2_PBE
    s_cmp_eq_u32 s7, 0
    s_cbranch_scc1 K2_SP6
K2_PBE:
    s_waitcnt vmcnt(0) lgkmcnt(0)
    v_perm_b32 v44, v65, v64, s61
    v_perm_b32 v45, v67, v66, s61
    v_perm_b32 v46, v69, v68, s61
    v_perm_b32 v47, v71, v70, s61
    v_perm_b32 v48, v73, v72, s61
    v_perm_b32 v49, v75, v74, s61
    v_perm_b32 v50, v77, v76, s61
    v_perm_b32 v51, v79, v78, s61
    v_perm_b32 v52, v81, v80, s61
    v_perm_b32 v53, v83, v82, s61
    v_xor_b32 v44, s1, v44
    v_xor_b32 v45, s1, v45
    v_xor_b32 v46, s1, v46
    v_xor_b32 v47, s1, v47
    v_xor_b32 v48, s1, v48
    v_xor_b32 v49, s1, v49
    v_xor_b32 v50, s1, v50
    v_xor_b32 v51, s1, v51
    v_xor_b32 v52, s1, v52
    v_xor_b32 v53, s1, v53
    v_or3_b32 v44, v44, v45, v46
    v_or3_b32 v44, v44, v47, v48
    v_or3_b32 v44, v44, v49, v50
    v_or3_b32 v44, v44, v51, v52
    v_or_b32 v44, v44, v53
    v_cmp_ne_u32 vcc, 0, v44
    s_cbranch_vccnz K2_PBR
    s_mov_b32 s94, 1
    v_and_b32 v64, 0xffff0000, v64
    v_and_b32 v65, 0xffff0000, v65
    v_and_b32 v66, 0xffff0000, v66
    v_and_b32 v67, 0xffff0000, v67
    v_and_b32 v68, 0xffff0000, v68
    v_and_b32 v69, 0xffff0000, v69
    v_and_b32 v70, 0xffff0000, v70
    v_and_b32 v71, 0xffff0000, v71
    v_and_b32 v72, 0xffff0000, v72
    v_and_b32 v73, 0xffff0000, v73
    v_and_b32 v74, 0xffff0000, v74
    v_and_b32 v75, 0xffff0000, v75
    v_and_b32 v76, 0xffff0000, v76
    v_and_b32 v77, 0xffff0000, v77
    v_and_b32 v78, 0xffff0000, v78
    v_and_b32 v79, 0xffff0000, v79
    v_and_b32 v80, 0xffff0000, v80
    v_and_b32 v81, 0xffff0000, v81
    v_and_b32 v82, 0xffff0000, v82
    v_and_b32 v83, 0xffff0000, v83
    s_cmp_eq_u32 s3, 6
    s_cbranch_scc1 K2_BG6e
    v_lshlrev_b32 v84, 16, v88
    v_and_b32 v85, 0xffff0000, v88
    v_lshlrev_b32 v86, 16, v89
    v_and_b32 v87, 0xffff0000, v89
    v_lshlrev_b32 v88, 16, v90
    v_and_b32 v89, 0xffff0000, v90
    v_lshlrev_b32 v90, 16, v91
    v_and_b32 v91, 0xffff0000, v91
    v_lshlrev_b32 v92, 16, v93
    v_and_b32 v93, 0xffff0000, v93
    v_pk_mul_f32 v[98:99], v[64:65], v[84:85]
    v_pk_fma_f32 v[98:99], v[66:67], v[86:87], v[98:99]
    v_pk_fma_f32 v[98:99], v[68:69], v[88:89], v[98:99]
    v_pk_fma_f32 v[98:99], v[70:71], v[90:91], v[98:99]
    v_pk_fma_f32 v[98:99], v[72:73], v[92:93], v[98:99]
    v_pk_mul_f32 v[84:85], v[74:75], v[84:85]
    v_pk_mul_f32 v[86:87], v[76:77], v[86:87]
    v_pk_mul_f32 v[88:89], v[78:79], v[88:89]
    v_pk_mul_f32 v[90:91], v[80:81], v[90:91]
    v_pk_mul_f32 v[92:93], v[82:83], v[92:93]
    v_pk_add_f32 v[96:97], v[84:85], v[86:87]
    v_pk_add_f32 v[96:97], v[96:97], v[88:89]
    v_pk_add_f32 v[96:97], v[96:97], v[90:91]
    v_pk_add_f32 v[96:97], v[96:97], v[92:93]
    v_pk_mul_f32 v[94:95], v[84:85], v[84:85]
    v_pk_fma_f32 v[94:95], v[86:87], v[86:87], v[94:95]
    v_pk_fma_f32 v[94:95], v[88:89], v[88:89], v[94:95]
    v_pk_fma_f32 v[94:95], v[90:91], v[90:91], v[94:95]
    v_pk_fma_f32 v[94:95], v[92:93], v[92:93], v[94:95]
    v_add_f32 v96, v96, v97
    v_add_f32 v97, v98, v99
    v_add_f32 v98, v94, v95
    v_add_f32_dpp v96, v96, v96 row_ror:8 row_mask:0xf bank_mask:0xf
    v_add_f32_dpp v97, v97, v97 row_ror:8 row_mask:0xf bank_mask:0xf
    v_add_f32_dpp v98, v98, v98 row_ror:8 row_mask:0xf bank_mask:0xf
    v_add_f32_dpp v96, v96, v96 row_ror:4 row_mask:0xf bank_mask:0xf
    v_add_f32_dpp v97, v97, v97 row_ror:4 row_mask:0xf bank_mask:0xf
    v_add_f32_dpp v98, v98, v98 row_ror:4 row_mask:0xf bank_mask:0xf
    v_add_f32_dpp v96, v96, v96 row_ror:2 row_mask:0xf bank_mask:0xf
    v_add_f32_dpp v97, v97, v97 row_ror:2 row_mask:0xf bank_mask:0xf
    v_add_f32_dpp v98, v98, v98 row_ror:2 row_mask:0xf bank_mask:0xf
    v_add_f32_dpp v96, v96, v96 row_ror:1 row_mask:0xf bank_mask:0xf
    v_add_f32_dpp v97, v97, v97 row_ror:1 row_mask:0xf bank_mask:0xf
    v_add_f32_dpp v98, v98, v98 row_ror:1 row_mask:0xf bank_mask:0xf
    v_add_f32_dpp v96, v96, v96 row_bcast:15 row_mask:0xa bank_mask:0xf
    v_add_f32_dpp v97, v97, v97 row_bcast:15 row_mask:0xa bank_mask:0xf
    v_add_f32_dpp v98, v98, v98 row_bcast:15 row_mask:0xa bank_mask:0xf
    v_add_f32_dpp v96, v96, v96 row_bcast:31 row_mask:0xc bank_mask:0xf
    v_add_f32_dpp v97, v97, v97 row_bcast:31 row_mask:0xc bank_mask:0xf
    v_add_f32_dpp v98, v98, v98 row_bcast:31 row_mask:0xc bank_mask:0xf
    v_mul_f32 v98, 0x40100000, v98
    v_sqrt_f32 v98, v98
    s_nop 0
    v_add_f32 v98, v98, v97
    s_branch K2_BGWe
K2_BG6e:
    v_readfirstlane_b32 s7, v84
    s_nop 1
    s_add_u32 s7, s7, s0
    s_sub_u32 s7, s7, 255
    v_ldexp_f32 v64, v64, s7
    v_ldexp_f32 v65, v65, s7
    v_ldexp_f32 v66, v66, s7
    v_ldexp_f32 v67, v67, s7
    v_ldexp_f32 v68, v68, s7
    v_ldexp_f32 v69, v69, s7
    v_ldexp_f32 v70, v70, s7
    v_ldexp_f32 v71, v71, s7
    v_ldexp_f32 v72, v72, s7
    v_ldexp_f32 v73, v73, s7
K2_BGWe:
    v_lshlrev_b32 v4, 3, v1
    s_cmp_eq_u32 s3, 6
    s_cselect_b32 s10, 0, 7680
    s_mov_b32 s11, 5120
    s_cselect_b32 s11, 10240, s11
    v_add_u32 v8, s10, v6
    v_add_u32 v9, s10, v4
    ds_write_b128 v8, v[64:67] offset:23040
    ds_write_b128 v8, v[68:71] offset:24064
    ds_write_b64 v9, v[72:73] offset:25088
    v_add_u32 v8, s11, v6
    v_add_u32 v9, s11, v4
    ds_write_b128 v8, v[74:77] offset:23040
    ds_write_b128 v8, v[78:81] offset:24064
    ds_write_b64 v9, v[82:83] offset:25088
    s_cbranch_scc1 K2_OUT
    ds_write_b128 v6, v[84:87] offset:25600
    ds_write_b128 v6, v[88:91] offset:26624
    ds_write_b64 v4, v[92:93] offset:27648
    v_mov_b32 v8, 0
    s_mov_b32 exec_lo, 0
    s_mov_b32 exec_hi, 0x80000000
    ds_write_b64 v8, v[96:97] offset:35840
    ds_write_b32 v8, v98 offset:35848
    ds_write_b32 v8, v8 offset:35888
    s_mov_b64 exec, -1
    s_branch K2_OUT
K2_PBR:
    buffer_load_dwordx4 v[64:67], v54, s[44:47], s95 offen sc1
    buffer_load_dwordx4 v[68:71], v54, s[44:47], s95 offen offset:16 sc1
    buffer_load_dwordx2 v[72:73], v55, s[44:47], s95 offen offset:2048 sc1
    buffer_load_dwordx4 v[74:77], v54, s[44:47], s96 offen sc1
    buffer_load_dwordx4 v[78:81], v54, s[44:47], s96 offen offset:16 sc1
    buffer_load_dwordx2 v[82:83], v55, s[44:47], s96 offen offset:2048 sc1
K2_OUT:
    v_lshlrev_b32 v2, 4, v0
    s_mul_i32 s8, s4, 16384
    s_add_u32 s8, s8, 5242880
    s_add_u32 s9, s8, 8192
    v_mov_b32 v19, s1
    v_mov_b32 v23, s1
    s_waitcnt lgkmcnt(0)
    s_barrier
    ds_read_u16 v18, v125 offset:32
    ds_read_b64 v[16:17], v5 offset:0
    ds_read_u16 v22, v125 offset:5152
    ds_read_b64 v[20:21], v5 offset:5120
    s_waitcnt lgkmcnt(3)
    v_or_b32 v18, s90, v18
    s_waitcnt lgkmcnt(2)
    buffer_store_dwordx4 v[16:19], v2, s[44:47], s8 offen sc1
    s_waitcnt lgkmcnt(1)
    v_or_b32 v22, s90, v22
    s_waitcnt lgkmcnt(0)
    buffer_store_dwordx4 v[20:23], v2, s[44:47], s9 offen sc1
    s_cmp_lg_u32 s3, 5
    s_cbranch_scc1 K2_NGO
    s_lshl_b32 s7, s2, 7
    s_add_u32 s7, s7, 622592
    s_mov_b64 exec, 1
    buffer_store_dword v19, v6, s[44:47], s7 offen sc1
    s_cmp_lg_u32 s2, 250
    s_cbranch_scc1 K2_NEP
    s_mov_b32 s12, 196608
    buffer_store_dword v19, v6, s[44:47], s12 offen sc1
K2_NEP:
    s_mov_b64 exec, -1
K2_NGO:
    s_cmp_lt_u32 s3, 6
    s_cbranch_scc1 K2_END
    s_cmp_eq_u32 s94, 1
    s_cbranch_scc1 K2_END
    s_mov_b32 s15, 65536
    s_waitcnt vmcnt(2)
    s_branch PB_CHK
PB_LOOP:
    buffer_load_dwordx4 v[64:67], v54, s[44:47], s95 offen sc1
    buffer_load_dwordx4 v[68:71], v54, s[44:47], s95 offen offset:16 sc1
    buffer_load_dwordx2 v[72:73], v55, s[44:47], s95 offen offset:2048 sc1
    buffer_load_dwordx4 v[74:77], v54, s[44:47], s96 offen sc1
    buffer_load_dwordx4 v[78:81], v54, s[44:47], s96 offen offset:16 sc1
    buffer_load_dwordx2 v[82:83], v55, s[44:47], s96 offen offset:2048 sc1
    s_waitcnt vmcnt(0)
PB_CHK:
    v_perm_b32 v44, v65, v64, s61
    v_perm_b32 v45, v67, v66, s61
    v_perm_b32 v46, v69, v68, s61
    v_perm_b32 v47, v71, v70, s61
    v_perm_b32 v48, v73, v72, s61
    v_perm_b32 v49, v75, v74, s61
    v_perm_b32 v50, v77, v76, s61
    v_perm_b32 v51, v79, v78, s61
    v_perm_b32 v52, v81, v80, s61
    v_perm_b32 v53, v83, v82, s61
    v_xor_b32 v44, s1, v44
    v_xor_b32 v45, s1, v45
    v_xor_b32 v46, s1, v46
    v_xor_b32 v47, s1, v47
    v_xor_b32 v48, s1, v48
    v_xor_b32 v49, s1, v49
    v_xor_b32 v50, s1, v50
    v_xor_b32 v51, s1, v51
    v_xor_b32 v52, s1, v52
    v_xor_b32 v53, s1, v53
    v_or3_b32 v44, v44, v45, v46
    v_or3_b32 v44, v44, v47, v48
    v_or3_b32 v44, v44, v49, v50
    v_or3_b32 v44, v44, v51, v52
    v_or_b32 v44, v44, v53
    v_cmp_ne_u32 vcc, 0, v44
    s_sub_u32 s15, s15, 1
    s_cbranch_scc1 PB_DONE
    s_cbranch_vccnz PB_LOOP
PB_DONE:
    v_and_b32 v64, 0xffff0000, v64
    v_and_b32 v65, 0xffff0000, v65
    v_and_b32 v66, 0xffff0000, v66
    v_and_b32 v67, 0xffff0000, v67
    v_and_b32 v68, 0xffff0000, v68
    v_and_b32 v69, 0xffff0000, v69
    v_and_b32 v70, 0xffff0000, v70
    v_and_b32 v71, 0xffff0000, v71
    v_and_b32 v72, 0xffff0000, v72
    v_and_b32 v73, 0xffff0000, v73
    v_and_b32 v74, 0xffff0000, v74
    v_and_b32 v75, 0xffff0000, v75
    v_and_b32 v76, 0xffff0000, v76
    v_and_b32 v77, 0xffff0000, v77
    v_and_b32 v78, 0xffff0000, v78
    v_and_b32 v79, 0xffff0000, v79
    v_and_b32 v80, 0xffff0000, v80
    v_and_b32 v81, 0xffff0000, v81
    v_and_b32 v82, 0xffff0000, v82
    v_and_b32 v83, 0xffff0000, v83
    s_cmp_eq_u32 s3, 6
    s_cbranch_scc1 K2_BG6
    v_lshlrev_b32 v84, 16, v88
    v_and_b32 v85, 0xffff0000, v88
    v_lshlrev_b32 v86, 16, v89
    v_and_b32 v87, 0xffff0000, v89
    v_lshlrev_b32 v88, 16, v90
    v_and_b32 v89, 0xffff0000, v90
    v_lshlrev_b32 v90, 16, v91
    v_and_b32 v91, 0xffff0000, v91
    v_lshlrev_b32 v92, 16, v93
    v_and_b32 v93, 0xffff0000, v93
    v_pk_mul_f32 v[98:99], v[64:65], v[84:85]
    v_pk_fma_f32 v[98:99], v[66:67], v[86:87], v[98:99]
    v_pk_fma_f32 v[98:99], v[68:69], v[88:89], v[98:99]
    v_pk_fma_f32 v[98:99], v[70:71], v[90:91], v[98:99]
    v_pk_fma_f32 v[98:99], v[72:73], v[92:93], v[98:99]
    v_pk_mul_f32 v[84:85], v[74:75], v[84:85]
    v_pk_mul_f32 v[86:87], v[76:77], v[86:87]
    v_pk_mul_f32 v[88:89], v[78:79], v[88:89]
    v_pk_mul_f32 v[90:91], v[80:81], v[90:91]
    v_pk_mul_f32 v[92:93], v[82:83], v[92:93]
    v_pk_add_f32 v[96:97], v[84:85], v[86:87]
    v_pk_add_f32 v[96:97], v[96:97], v[88:89]
    v_pk_add_f32 v[96:97], v[96:97], v[90:91]
    v_pk_add_f32 v[96:97], v[96:97], v[92:93]
    v_pk_mul_f32 v[94:95], v[84:85], v[84:85]
    v_pk_fma_f32 v[94:95], v[86:87], v[86:87], v[94:95]
    v_pk_fma_f32 v[94:95], v[88:89], v[88:89], v[94:95]
    v_pk_fma_f32 v[94:95], v[90:91], v[90:91], v[94:95]
    v_pk_fma_f32 v[94:95], v[92:93], v[92:93], v[94:95]
    v_add_f32 v96, v96, v97
    v_add_f32 v97, v98, v99
    v_add_f32 v98, v94, v95
    v_add_f32_dpp v96, v96, v96 row_ror:8 row_mask:0xf bank_mask:0xf
    v_add_f32_dpp v97, v97, v97 row_ror:8 row_mask:0xf bank_mask:0xf
    v_add_f32_dpp v98, v98, v98 row_ror:8 row_mask:0xf bank_mask:0xf
    v_add_f32_dpp v96, v96, v96 row_ror:4 row_mask:0xf bank_mask:0xf
    v_add_f32_dpp v97, v97, v97 row_ror:4 row_mask:0xf bank_mask:0xf
    v_add_f32_dpp v98, v98, v98 row_ror:4 row_mask:0xf bank_mask:0xf
    v_add_f32_dpp v96, v96, v96 row_ror:2 row_mask:0xf bank_mask:0xf
    v_add_f32_dpp v97, v97, v97 row_ror:2 row_mask:0xf bank_mask:0xf
    v_add_f32_dpp v98, v98, v98 row_ror:2 row_mask:0xf bank_mask:0xf
    v_add_f32_dpp v96, v96, v96 row_ror:1 row_mask:0xf bank_mask:0xf
    v_add_f32_dpp v97, v97, v97 row_ror:1 row_mask:0xf bank_mask:0xf
    v_add_f32_dpp v98, v98, v98 row_ror:1 row_mask:0xf bank_mask:0xf
    v_add_f32_dpp v96, v96, v96 row_bcast:15 row_mask:0xa bank_mask:0xf
    v_add_f32_dpp v97, v97, v97 row_bcast:15 row_mask:0xa bank_mask:0xf
    v_add_f32_dpp v98, v98, v98 row_bcast:15 row_mask:0xa bank_mask:0xf
    v_add_f32_dpp v96, v96, v96 row_bcast:31 row_mask:0xc bank_mask:0xf
    v_add_f32_dpp v97, v97, v97 row_bcast:31 row_mask:0xc bank_mask:0xf
    v_add_f32_dpp v98, v98, v98 row_bcast:31 row_mask:0xc bank_mask:0xf
    v_mul_f32 v98, 0x40100000, v98
    v_sqrt_f32 v98, v98
    s_nop 0
    v_add_f32 v98, v98, v97
    s_branch K2_BGW
K2_BG6:
    v_readfirstlane_b32 s7, v84
    s_nop 1
    s_add_u32 s7, s7, s0
    s_sub_u32 s7, s7, 255
    v_ldexp_f32 v64, v64, s7
    v_ldexp_f32 v65, v65, s7
    v_ldexp_f32 v66, v66, s7
    v_ldexp_f32 v67, v67, s7
    v_ldexp_f32 v68, v68, s7
    v_ldexp_f32 v69, v69, s7
    v_ldexp_f32 v70, v70, s7
    v_ldexp_f32 v71, v71, s7
    v_ldexp_f32 v72, v72, s7
    v_ldexp_f32 v73, v73, s7
K2_BGW:
    v_lshlrev_b32 v4, 3, v1
    s_cmp_eq_u32 s3, 6
    s_cselect_b32 s10, 0, 7680
    s_mov_b32 s11, 5120
    s_cselect_b32 s11, 10240, s11
    v_add_u32 v8, s10, v6
    v_add_u32 v9, s10, v4
    ds_write_b128 v8, v[64:67] offset:23040
    ds_write_b128 v8, v[68:71] offset:24064
    ds_write_b64 v9, v[72:73] offset:25088
    v_add_u32 v8, s11, v6
    v_add_u32 v9, s11, v4
    ds_write_b128 v8, v[74:77] offset:23040
    ds_write_b128 v8, v[78:81] offset:24064
    ds_write_b64 v9, v[82:83] offset:25088
    s_cbranch_scc1 K2_END
    ds_write_b128 v6, v[84:87] offset:25600
    ds_write_b128 v6, v[88:91] offset:26624
    ds_write_b64 v4, v[92:93] offset:27648
    v_mov_b32 v8, 0
    s_mov_b32 exec_lo, 0
    s_mov_b32 exec_hi, 0x80000000
    ds_write_b64 v8, v[96:97] offset:35840
    ds_write_b32 v8, v98 offset:35848
    ds_write_b32 v8, v8 offset:35888
    s_mov_b64 exec, -1
K2_END:
    v_lshlrev_b32 v5, 4, v1
    v_lshlrev_b32 v35, 2, v1
    s_cmp_ge_u32 s3, 5
    s_cbranch_scc1 K3_NT
    ds_read_b128 v[84:87], v5 offset:46336
    ds_read_b128 v[88:91], v5 offset:47360
    ds_read_b128 v[92:95], v5 offset:52480
    ds_read_b128 v[96:99], v5 offset:53504
    ds_read_b128 v[100:103], v5 offset:54528
    ds_read_b128 v[104:107], v5 offset:55552
K3_NT:
    v_mov_b32 v30, v120
    v_mov_b32 v31, v121
    v_mov_b32 v32, v122
    v_mov_b32 v33, v123
    v_mov_b32 v34, v124
    s_lshl_b32 s5, s3, 8
    s_add_u32 s5, s5, s4
    s_mul_i32 s6, s5, 1280
    s_and_b32 s11, s3, 3
    s_lshr_b32 s10, s3, 2
    s_lshl_b32 s10, s10, 4
    v_lshrrev_b32 v2, 2, v1
    v_add_u32 v2, s10, v2
    v_add_u32 v3, 32, v2
    v_sub_u32 v4, 64, v2
    s_cmp_eq_u32 s11, 0
    s_cselect_b64 s[92:93], -1, 0
    v_cmp_ne_u32 vcc, 0, v2
    s_nop 1
    s_and_b64 vcc, vcc, s[92:93]
    v_cndmask_b32 v3, v3, v4, vcc
    s_mov_b32 s92, 0xaaaaaaaa
    s_mov_b32 s93, 0xaaaaaaaa
    s_and_b64 s[92:93], s[92:93], vcc
    v_and_b32 v4, 3, v1
    v_lshlrev_b32 v4, 4, v4
    v_lshl_add_u32 v20, v2, 14, v4
    v_lshl_add_u32 v21, v3, 14, v4
    v_cmp_lt_u32 vcc, 31, v4
    s_nop 1
    v_cndmask_b32 v27, v2, v3, vcc
    v_and_b32 v28, 1, v1
    s_mul_i32 s14, s11, 1048576
    s_lshl_b32 s8, s4, 6
    s_add_u32 s14, s14, s8
    s_add_u32 s14, s14, 5242880
    s_mov_b32 s64, s36
    s_mov_b32 s65, s37
    s_mov_b32 s66, 0x280000
    s_mov_b32 s67, 0x20000
    v_and_b32 v4, 15, v1
    v_lshrrev_b32 v7, 4, v1
    s_mov_b32 s74, 0x00000000
    s_mov_b32 s75, 0x40c00000
    s_mov_b32 s76, 0x40000000
    s_mov_b32 s77, 0x41000000
    s_mov_b32 s78, 0x40800000
    s_mov_b32 s12, 0x3ea1e89b
    s_mul_i32 s7, s4, s11
    v_cvt_f32_u32 v52, v27
    v_cvt_f32_u32 v53, s7
    v_cvt_f32_u32 v29, v28
    v_mul_f32 v52, 0x3acccccd, v52
    v_mul_f32 v53, 0x3a000000, v53
    v_mul_f32 v2, 0x40a00000, v29
    v_fma_f32 v3, v2, v52, v53
    v_fma_f32 v53, -v2, v52, v53
    v_fma_f32 v29, v29, -2.0, 1.0
    v_fma_f32 v54, v52, s74, v3
    v_fma_f32 v55, v52, s75, v53
    v_fma_f32 v56, v52, s76, v3
    v_fma_f32 v57, v52, s77, v53
    v_fma_f32 v58, v52, s78, v3
    v_cos_f32 v108, v54
    v_sin_f32 v109, v54
    v_cos_f32 v110, v55
    v_sin_f32 v111, v55
    v_cos_f32 v112, v56
    v_sin_f32 v113, v56
    v_cos_f32 v114, v57
    v_sin_f32 v115, v57
    v_cos_f32 v116, v58
    v_sin_f32 v117, v58
    v_pk_mul_f32 v[108:109], v[108:109], s[12:13] op_sel_hi:[1,0]
    v_pk_mul_f32 v[110:111], v[110:111], s[12:13] op_sel_hi:[1,0]
    v_pk_mul_f32 v[112:113], v[112:113], s[12:13] op_sel_hi:[1,0]
    v_pk_mul_f32 v[114:115], v[114:115], s[12:13] op_sel_hi:[1,0]
    v_pk_mul_f32 v[116:117], v[116:117], s[12:13] op_sel_hi:[1,0]
    v_and_b32 v52, 3, v27
    v_mul_u32_u24 v52, 80, v52
    v_and_b32 v53, 60, v27
    s_mul_i32 s7, s11, 320
    v_add3_u32 v52, v52, v53, s7
    s_movk_i32 s13, 6400
    v_mul_u32_u24 v53, s13, v28
    v_add_u32 v2, v53, v52
    v_sub_u32 v3, v52, v53
    v_mul_u32_u24 v52, 80, v4
    v_lshl_add_u32 v52, v7, 4, v52
    s_mul_i32 s13, s3, 2560
    v_add_u32 v6, s13, v52
    v_mul_u32_u24 v52, 20, v4
    s_movk_i32 s13, 320
    v_mad_u32_u24 v52, v7, s13, v52
    s_lshl_b32 s13, s3, 2
    v_add_u32 v7, s13, v52
    s_mul_i32 s13, s3, 1280
    v_add_u32 v4, s13, v5
    v_add_u32 v41, s13, v35
    v_lshlrev_b32 v36, 3, v1
    s_sleep 15
E2_NS:
    s_mov_b32 s15, 65536
    buffer_load_dwordx4 v[76:79], v20, s[44:47], s14 offen
    buffer_load_dwordx4 v[80:83], v21, s[44:47], s14 offen
    s_waitcnt vmcnt(0)
    s_branch E2_CHK
E2_LOOP:
    buffer_load_dwordx4 v[76:79], v20, s[44:47], s14 offen sc1
    buffer_load_dwordx4 v[80:83], v21, s[44:47], s14 offen sc1
    s_waitcnt vmcnt(0)
E2_CHK:
    v_perm_b32 v37, v82, v78, s89
    v_xor_b32 v38, s1, v79
    v_xor_b32 v39, s1, v83
    v_xor_b32 v37, s88, v37
    v_or3_b32 v37, v37, v38, v39
    v_cmp_ne_u32 vcc, 0, v37
    s_sub_u32 s15, s15, 1
    s_cbranch_scc1 E2_DONE
    s_cbranch_vccz E2_DONE
    s_mov_b64 exec, vcc
    s_branch E2_LOOP
E2_DONE:
    s_mov_b64 exec, -1
    s_cmp_lg_u32 s11, 0
    s_cbranch_scc1 K3_NSW
    v_cndmask_b32 v44, v76, v80, s[92:93]
    v_cndmask_b32 v45, v77, v81, s[92:93]
    v_cndmask_b32 v46, v78, v82, s[92:93]
    v_cndmask_b32 v48, v80, v76, s[92:93]
    v_cndmask_b32 v49, v81, v77, s[92:93]
    v_cndmask_b32 v50, v82, v78, s[92:93]
    s_mov_b32 vcc_lo, 0x33333333
    s_mov_b32 vcc_hi, 0x33333333
    v_cndmask_b32_dpp v8, v48, v44, vcc quad_perm:[2,3,0,1] row_mask:0xf bank_mask:0xf
    v_cndmask_b32_dpp v9, v49, v45, vcc quad_perm:[2,3,0,1] row_mask:0xf bank_mask:0xf
    v_cndmask_b32_dpp v10, v50, v46, vcc quad_perm:[2,3,0,1] row_mask:0xf bank_mask:0xf
    s_not_b64 vcc, vcc
    v_cndmask_b32_dpp v12, v44, v48, vcc quad_perm:[2,3,0,1] row_mask:0xf bank_mask:0xf
    v_cndmask_b32_dpp v13, v45, v49, vcc quad_perm:[2,3,0,1] row_mask:0xf bank_mask:0xf
    v_cndmask_b32_dpp v14, v46, v50, vcc quad_perm:[2,3,0,1] row_mask:0xf bank_mask:0xf
    s_branch K3_SW2
K3_NSW:
    s_mov_b32 vcc_lo, 0x33333333
    s_mov_b32 vcc_hi, 0x33333333
    v_cndmask_b32_dpp v8, v80, v76, vcc quad_perm:[2,3,0,1] row_mask:0xf bank_mask:0xf
    v_cndmask_b32_dpp v9, v81, v77, vcc quad_perm:[2,3,0,1] row_mask:0xf bank_mask:0xf
    v_cndmask_b32_dpp v10, v82, v78, vcc quad_perm:[2,3,0,1] row_mask:0xf bank_mask:0xf
    s_not_b64 vcc, vcc
    v_cndmask_b32_dpp v12, v76, v80, vcc quad_perm:[2,3,0,1] row_mask:0xf bank_mask:0xf
    v_cndmask_b32_dpp v13, v77, v81, vcc quad_perm:[2,3,0,1] row_mask:0xf bank_mask:0xf
    v_cndmask_b32_dpp v14, v78, v82, vcc quad_perm:[2,3,0,1] row_mask:0xf bank_mask:0xf
K3_SW2:
    v_perm_b32 v10, v14, v10, s61
    v_mov_b32_dpp v44, v8 quad_perm:[1,0,3,2] row_mask:0xf bank_mask:0xf
    v_mov_b32_dpp v45, v9 quad_perm:[1,0,3,2] row_mask:0xf bank_mask:0xf
    v_mov_b32_dpp v46, v12 quad_perm:[1,0,3,2] row_mask:0xf bank_mask:0xf
    v_mov_b32_dpp v47, v13 quad_perm:[1,0,3,2] row_mask:0xf bank_mask:0xf
    v_mov_b32_dpp v48, v10 quad_perm:[1,0,3,2] row_mask:0xf bank_mask:0xf
    v_fma_mix_f32 v18, v8, v29, v44 op_sel_hi:[1,0,1]
    v_fma_mix_f32 v19, v8, v29, v44 op_sel:[1,0,1] op_sel_hi:[1,0,1]
    v_fma_mix_f32 v20, v9, v29, v45 op_sel_hi:[1,0,1]
    v_fma_mix_f32 v21, v9, v29, v45 op_sel:[1,0,1] op_sel_hi:[1,0,1]
    v_fma_mix_f32 v22, v12, v29, v46 op_sel_hi:[1,0,1]
    v_fma_mix_f32 v23, v12, v29, v46 op_sel:[1,0,1] op_sel_hi:[1,0,1]
    v_fma_mix_f32 v24, v13, v29, v47 op_sel_hi:[1,0,1]
    v_fma_mix_f32 v25, v13, v29, v47 op_sel:[1,0,1] op_sel_hi:[1,0,1]
    v_fma_mix_f32 v26, v10, v29, v48 op_sel_hi:[1,0,1]
    v_fma_mix_f32 v27, v10, v29, v48 op_sel:[1,0,1] op_sel_hi:[1,0,1]
    s_nop 0
    v_pk_add_f32 v[8:9], v[20:21], v[26:27]
    v_pk_add_f32 v[10:11], v[22:23], v[24:25]
    v_pk_add_f32 v[12:13], v[20:21], v[26:27] neg_lo:[0,1] neg_hi:[0,1]
    v_pk_add_f32 v[14:15], v[22:23], v[24:25] neg_lo:[0,1] neg_hi:[0,1]
    v_pk_fma_f32 v[16:17], v[8:9], s[70:71], v[18:19] op_sel_hi:[1,0,1]
    v_pk_fma_f32 v[28:29], v[8:9], s[70:71], v[18:19] op_sel:[0,1,0] op_sel_hi:[1,1,1]
    v_pk_add_f32 v[42:43], v[18:19], v[8:9]
    v_pk_fma_f32 v[16:17], v[10:11], s[70:71], v[16:17] op_sel:[0,1,0] op_sel_hi:[1,1,1]
    v_pk_fma_f32 v[28:29], v[10:11], s[70:71], v[28:29] op_sel_hi:[1,0,1]
    v_pk_add_f32 v[42:43], v[42:43], v[10:11]
    v_pk_mul_f32 v[8:9], v[12:13], s[72:73] op_sel_hi:[1,0]
    v_pk_mul_f32 v[10:11], v[12:13], s[72:73] op_sel:[0,1] op_sel_hi:[1,1]
    v_pk_fma_f32 v[8:9], v[14:15], s[72:73], v[8:9] op_sel:[0,1,0] op_sel_hi:[1,1,1]
    v_pk_fma_f32 v[10:11], v[14:15], s[72:73], v[10:11] op_sel_hi:[1,0,1] neg_lo:[1,0,0] neg_hi:[1,0,0]
    v_pk_add_f32 v[44:45], v[8:9], v[16:17] op_sel:[1,0] op_sel_hi:[0,1] neg_lo:[1,0]
    v_pk_add_f32 v[50:51], v[8:9], v[16:17] op_sel:[1,0] op_sel_hi:[0,1] neg_hi:[1,0]
    v_pk_add_f32 v[46:47], v[10:11], v[28:29] op_sel:[1,0] op_sel_hi:[0,1] neg_lo:[1,0]
    v_pk_add_f32 v[48:49], v[10:11], v[28:29] op_sel:[1,0] op_sel_hi:[0,1] neg_hi:[1,0]
    v_pk_mul_f32 v[18:19], v[42:43], v[108:109] op_sel_hi:[1,0]
    v_pk_mul_f32 v[20:21], v[44:45], v[110:111] op_sel_hi:[1,0]
    v_pk_mul_f32 v[22:23], v[46:47], v[112:113] op_sel_hi:[1,0]
    v_pk_mul_f32 v[24:25], v[48:49], v[114:115] op_sel_hi:[1,0]
    v_pk_mul_f32 v[26:27], v[50:51], v[116:117] op_sel_hi:[1,0]
    v_pk_fma_f32 v[18:19], v[42:43], v[108:109], v[18:19] op_sel:[1,1,0] op_sel_hi:[0,1,1] neg_lo:[1,0,0]
    v_pk_fma_f32 v[20:21], v[44:45], v[110:111], v[20:21] op_sel:[1,1,0] op_sel_hi:[0,1,1] neg_lo:[1,0,0]
    v_pk_fma_f32 v[22:23], v[46:47], v[112:113], v[22:23] op_sel:[1,1,0] op_sel_hi:[0,1,1] neg_lo:[1,0,0]
    v_pk_fma_f32 v[24:25], v[48:49], v[114:115], v[24:25] op_sel:[1,1,0] op_sel_hi:[0,1,1] neg_lo:[1,0,0]
    v_pk_fma_f32 v[26:27], v[50:51], v[116:117], v[26:27] op_sel:[1,1,0] op_sel_hi:[0,1,1] neg_lo:[1,0,0]
    v_cvt_pk_f16_f32 v8, v18, v19
    v_cvt_pk_f16_f32 v9, v20, v21
    v_cvt_pk_f16_f32 v10, v22, v23
    v_cvt_pk_f16_f32 v11, v24, v25
    v_cvt_pk_f16_f32 v12, v26, v27
    ds_write2st64_b32 v2, v8, v10 offset0:40 offset1:50
    ds_write2st64_b32 v3, v9, v11 offset0:70 offset1:80
    ds_write_b32 v2, v12 offset:15360
    s_waitcnt lgkmcnt(0)
    s_barrier
    s_cmp_ge_u32 s3, 5
    s_cbranch_scc1 K3_PF
    ds_read_b128 v[8:11], v6 offset:10240
    ds_read_b128 v[12:15], v6 offset:11520
    s_waitcnt lgkmcnt(1)
    v_mfma_f32_16x16x32_f16 v[108:111], v[8:11], v[84:87], 0
    v_mfma_f32_16x16x32_f16 v[112:115], v[8:11], v[88:91], 0
    s_waitcnt lgkmcnt(0)
    v_mfma_f32_16x16x32_f16 v[116:119], v[12:15], v[84:87], 0
    v_mfma_f32_16x16x32_f16 v[120:123], v[12:15], v[88:91], 0
    s_nop 3
    v_pk_mul_f32 v[16:17], v[108:109], v[92:93]
    v_pk_mul_f32 v[20:21], v[112:113], v[92:93]
    v_pk_mul_f32 v[18:19], v[110:111], v[94:95]
    v_pk_mul_f32 v[22:23], v[114:115], v[94:95]
    v_pk_fma_f32 v[16:17], v[112:113], v[96:97], v[16:17] neg_lo:[1,0,0] neg_hi:[1,0,0]
    v_pk_fma_f32 v[20:21], v[108:109], v[96:97], v[20:21]
    v_pk_fma_f32 v[18:19], v[114:115], v[98:99], v[18:19] neg_lo:[1,0,0] neg_hi:[1,0,0]
    v_pk_fma_f32 v[22:23], v[110:111], v[98:99], v[22:23]
    v_cvt_pk_f16_f32 v8, v16, v20
    v_cvt_pk_f16_f32 v9, v17, v21
    v_cvt_pk_f16_f32 v10, v18, v22
    v_cvt_pk_f16_f32 v11, v19, v23
    s_nop 1
    v_mfma_f32_16x16x32_f16 v[108:111], v[100:103], v[8:11], 0
    v_mfma_f32_16x16x32_f16 v[112:115], v[104:107], v[8:11], 0
    v_pk_mul_f32 v[16:17], v[116:117], v[92:93]
    v_pk_mul_f32 v[20:21], v[120:121], v[92:93]
    v_pk_mul_f32 v[18:19], v[118:119], v[94:95]
    v_pk_mul_f32 v[22:23], v[122:123], v[94:95]
    v_pk_fma_f32 v[16:17], v[120:121], v[96:97], v[16:17] neg_lo:[1,0,0] neg_hi:[1,0,0]
    v_pk_fma_f32 v[20:21], v[116:117], v[96:97], v[20:21]
    v_pk_fma_f32 v[18:19], v[122:123], v[98:99], v[18:19] neg_lo:[1,0,0] neg_hi:[1,0,0]
    v_pk_fma_f32 v[22:23], v[118:119], v[98:99], v[22:23]
    v_cvt_pk_f16_f32 v12, v16, v20
    v_cvt_pk_f16_f32 v13, v17, v21
    v_cvt_pk_f16_f32 v14, v18, v22
    v_cvt_pk_f16_f32 v15, v19, v23
    s_nop 1
    v_mfma_f32_16x16x32_f16 v[116:119], v[100:103], v[12:15], 0
    v_mfma_f32_16x16x32_f16 v[120:123], v[104:107], v[12:15], 0
    s_nop 6
    v_cvt_pk_bf16_f32 v16, v108, v116
    v_cvt_pk_bf16_f32 v17, v109, v117
    v_cvt_pk_bf16_f32 v18, v110, v118
    v_cvt_pk_bf16_f32 v19, v111, v119
    v_cvt_pk_bf16_f32 v20, v112, v120
    v_cvt_pk_bf16_f32 v21, v113, v121
    v_cvt_pk_bf16_f32 v22, v114, v122
    v_cvt_pk_bf16_f32 v23, v115, v123
    ds_write2st64_b32 v7, v16, v17 offset0:0 offset1:5
    ds_write2st64_b32 v7, v18, v19 offset0:10 offset1:15
    ds_write2st64_b32 v7, v20, v21 offset0:20 offset1:25
    ds_write2st64_b32 v7, v22, v23 offset0:30 offset1:35
    s_branch K3_P2E
K3_PF:
    s_cmp_eq_u32 s3, 7
    s_cbranch_scc1 K3_P2E
    s_mov_b32 s58, 0x21c000
    s_mov_b32 s59, 0x20000
    s_lshr_b32 s8, s2, 3
    s_and_b32 s9, s2, 7
    s_lshl_b32 s13, s9, 7
    s_cmp_eq_u32 s3, 6
    s_cbranch_scc1 PFW3_6
    s_cmp_lt_u32 s9, 3
    s_cbranch_scc1 PFW3_0_0
    s_mov_b32 s56, s30
    s_mov_b32 s57, s31
    s_movk_i32 s10, 1280
    s_mul_i32 s12, s8, 69120
    s_add_u32 s12, s12, s13
    v_mul_u32_u24 v9, s10, v1
    s_sub_u32 s12, s12, 384
    s_mov_b32 exec_hi, 0x3fffff
    buffer_load_dword v126, v9, s[56:59], s12 offen offset:640
    s_mov_b64 exec, -1
PFW3_0_0:
    s_branch PFW3_E
PFW3_6:
    s_cmp_lt_u32 s9, 3
    s_cbranch_scc1 PFW3_1_0
    s_mov_b32 s56, s30
    s_mov_b32 s57, s31
    s_movk_i32 s10, 1280
    s_mul_i32 s12, s8, 69120
    s_add_u32 s12, s12, s13
    v_mul_u32_u24 v9, s10, v1
    s_sub_u32 s12, s12, 384
    s_mov_b32 exec_hi, 0x3fffff
    buffer_load_dword v126, v9, s[56:59], s12 offen offset:0
    s_mov_b64 exec, -1
PFW3_1_0:
PFW3_E:
K3_P2E:
    v_mov_b32 v22, 0
    ds_read_b128 v[42:45], v5 offset:23040
    ds_read_b128 v[46:49], v5 offset:24064
    ds_read_b64 v[50:51], v36 offset:25088
    ds_read_b128 v[52:55], v5 offset:25600
    ds_read_b128 v[56:59], v5 offset:26624
    ds_read_b64 v[60:61], v36 offset:27648
    ds_read_b64 v[26:27], v22 offset:35840
    ds_read_b32 v23, v22 offset:35848
    ds_read_b128 v[62:65], v5 offset:28160
    ds_read_b128 v[66:69], v5 offset:29184
    ds_read_b64 v[70:71], v36 offset:30208
    ds_read_b128 v[72:75], v5 offset:30720
    ds_read_b128 v[76:79], v5 offset:31744
    ds_read_b64 v[80:81], v36 offset:32768
    v_lshlrev_b32 v84, 16, v30
    v_and_b32 v85, 0xffff0000, v30
    v_lshlrev_b32 v86, 16, v31
    v_and_b32 v87, 0xffff0000, v31
    v_lshlrev_b32 v88, 16, v32
    v_and_b32 v89, 0xffff0000, v32
    v_lshlrev_b32 v90, 16, v33
    v_and_b32 v91, 0xffff0000, v33
    v_lshlrev_b32 v92, 16, v34
    v_and_b32 v93, 0xffff0000, v34
    s_lshl_b32 s7, s3, 2
    v_mov_b32 v28, s7
    v_mov_b32 v29, 1
    s_waitcnt lgkmcnt(0)
    s_setprio 3
    s_barrier
    ds_read_b128 v[8:11], v4
    ds_read_b32 v12, v41 offset:1024
    ds_read_b128 v[94:97], v5 offset:33280
    ds_read_b128 v[98:101], v5 offset:34304
    ds_read_b64 v[102:103], v36 offset:35328
    s_waitcnt lgkmcnt(3)
    v_lshlrev_b32 v104, 16, v8
    v_and_b32 v105, 0xffff0000, v8
    v_lshlrev_b32 v106, 16, v9
    v_and_b32 v107, 0xffff0000, v9
    v_lshlrev_b32 v108, 16, v10
    v_and_b32 v109, 0xffff0000, v10
    v_lshlrev_b32 v110, 16, v11
    v_and_b32 v111, 0xffff0000, v11
    v_lshlrev_b32 v112, 16, v12
    v_and_b32 v113, 0xffff0000, v12
    v_pk_mul_f32 v[104:105], v[104:105], v[42:43]
    v_pk_mul_f32 v[106:107], v[106:107], v[44:45]
    v_pk_mul_f32 v[108:109], v[108:109], v[46:47]
    v_pk_mul_f32 v[110:111], v[110:111], v[48:49]
    v_pk_mul_f32 v[112:113], v[112:113], v[50:51]
    v_cvt_pk_bf16_f32 v104, 0, v104
    v_cvt_pk_bf16_f32 v105, 0, v105
    v_cvt_pk_bf16_f32 v106, 0, v106
    v_cvt_pk_bf16_f32 v107, 0, v107
    v_cvt_pk_bf16_f32 v108, 0, v108
    v_cvt_pk_bf16_f32 v109, 0, v109
    v_cvt_pk_bf16_f32 v110, 0, v110
    v_cvt_pk_bf16_f32 v111, 0, v111
    v_cvt_pk_bf16_f32 v112, 0, v112
    v_cvt_pk_bf16_f32 v113, 0, v113
    v_pk_add_f32 v[104:105], v[104:105], v[84:85]
    v_pk_add_f32 v[106:107], v[106:107], v[86:87]
    v_pk_add_f32 v[108:109], v[108:109], v[88:89]
    v_pk_add_f32 v[110:111], v[110:111], v[90:91]
    v_pk_add_f32 v[112:113], v[112:113], v[92:93]
    v_cvt_pk_bf16_f32 v44, v104, v105
    v_cvt_pk_bf16_f32 v45, v106, v107
    v_cvt_pk_bf16_f32 v46, v108, v109
    v_cvt_pk_bf16_f32 v48, v110, v111
    v_cvt_pk_bf16_f32 v49, v112, v113
    v_lshlrev_b32 v84, 16, v44
    v_and_b32 v85, 0xffff0000, v44
    v_lshlrev_b32 v86, 16, v45
    v_and_b32 v87, 0xffff0000, v45
    v_lshlrev_b32 v88, 16, v46
    v_and_b32 v89, 0xffff0000, v46
    v_lshlrev_b32 v90, 16, v48
    v_and_b32 v91, 0xffff0000, v48
    v_lshlrev_b32 v92, 16, v49
    v_and_b32 v93, 0xffff0000, v49
    v_readfirstlane_b32 s12, v84
    s_nop 1
    v_pk_add_f32 v[104:105], v[84:85], s[12:13] op_sel_hi:[1,0] neg_lo:[0,1] neg_hi:[0,1]
    v_pk_add_f32 v[106:107], v[86:87], s[12:13] op_sel_hi:[1,0] neg_lo:[0,1] neg_hi:[0,1]
    v_pk_add_f32 v[108:109], v[88:89], s[12:13] op_sel_hi:[1,0] neg_lo:[0,1] neg_hi:[0,1]
    v_pk_add_f32 v[110:111], v[90:91], s[12:13] op_sel_hi:[1,0] neg_lo:[0,1] neg_hi:[0,1]
    v_pk_add_f32 v[112:113], v[92:93], s[12:13] op_sel_hi:[1,0] neg_lo:[0,1] neg_hi:[0,1]
    v_pk_add_f32 v[14:15], v[104:105], v[106:107]
    v_pk_mul_f32 v[20:21], v[104:105], v[104:105]
    v_pk_mul_f32 v[24:25], v[104:105], v[52:53]
    v_pk_fma_f32 v[20:21], v[106:107], v[106:107], v[20:21]
    v_pk_fma_f32 v[24:25], v[106:107], v[54:55], v[24:25]
    v_pk_add_f32 v[14:15], v[14:15], v[108:109]
    v_pk_fma_f32 v[20:21], v[108:109], v[108:109], v[20:21]
    v_pk_fma_f32 v[24:25], v[108:109], v[56:57], v[24:25]
    v_pk_add_f32 v[14:15], v[14:15], v[110:111]
    v_pk_fma_f32 v[20:21], v[110:111], v[110:111], v[20:21]
    v_pk_fma_f32 v[24:25], v[110:111], v[58:59], v[24:25]
    v_pk_add_f32 v[14:15], v[14:15], v[112:113]
    v_pk_fma_f32 v[20:21], v[112:113], v[112:113], v[20:21]
    v_pk_fma_f32 v[24:25], v[112:113], v[60:61], v[24:25]
    v_add_f32 v16, v14, v15
    v_add_f32 v17, v20, v21
    v_add_f32 v18, v24, v25
    v_add_f32_dpp v16, v16, v16 row_ror:8 row_mask:0xf bank_mask:0xf
    v_add_f32_dpp v17, v17, v17 row_ror:8 row_mask:0xf bank_mask:0xf
    v_add_f32_dpp v18, v18, v18 row_ror:8 row_mask:0xf bank_mask:0xf
    v_add_f32_dpp v16, v16, v16 row_ror:4 row_mask:0xf bank_mask:0xf
    v_add_f32_dpp v17, v17, v17 row_ror:4 row_mask:0xf bank_mask:0xf
    v_add_f32_dpp v18, v18, v18 row_ror:4 row_mask:0xf bank_mask:0xf
    v_add_f32_dpp v16, v16, v16 row_ror:2 row_mask:0xf bank_mask:0xf
    v_add_f32_dpp v17, v17, v17 row_ror:2 row_mask:0xf bank_mask:0xf
    v_add_f32_dpp v18, v18, v18 row_ror:2 row_mask:0xf bank_mask:0xf
    v_add_f32_dpp v16, v16, v16 row_ror:1 row_mask:0xf bank_mask:0xf
    v_add_f32_dpp v17, v17, v17 row_ror:1 row_mask:0xf bank_mask:0xf
    v_add_f32_dpp v18, v18, v18 row_ror:1 row_mask:0xf bank_mask:0xf
    v_add_f32_dpp v16, v16, v16 row_bcast:15 row_mask:0xa bank_mask:0xf
    v_add_f32_dpp v17, v17, v17 row_bcast:15 row_mask:0xa bank_mask:0xf
    v_add_f32_dpp v18, v18, v18 row_bcast:15 row_mask:0xa bank_mask:0xf
    v_add_f32_dpp v16, v16, v16 row_bcast:31 row_mask:0xc bank_mask:0xf
    v_add_f32_dpp v17, v17, v17 row_bcast:31 row_mask:0xc bank_mask:0xf
    v_add_f32_dpp v18, v18, v18 row_bcast:31 row_mask:0xc bank_mask:0xf
    v_mul_f32 v16, 0x3acccccd, v16
    v_mul_f32 v17, 0x3acccccd, v17
    v_fma_f32 v17, -v16, v16, v17
    v_add_f32 v16, s12, v16
    v_max_f32 v17, 0, v17
    v_cvt_pk_bf16_f32 v16, 0, v16
    v_cvt_pk_bf16_f32 v17, 0, v17
    v_add_f32 v17, 0x3727c5ac, v17
    v_cvt_pk_bf16_f32 v17, 0, v17
    v_sqrt_f32 v17, v17
    v_subrev_f32 v19, s12, v16
    v_cvt_pk_bf16_f32 v17, 0, v17
    v_rcp_f32 v17, v17
    v_fma_f32 v18, -v19, v26, v18
    s_and_b32 s7, s3, 1
    s_lshl_b32 s7, s7, 4
    s_lshr_b32 s7, s1, s7
    s_and_b32 s7, s7, 0xffff
    v_fma_f32 v18, v18, v17, v27
    v_cmp_ge_f32 s[62:63], v18, v23
    v_cvt_pk_bf16_f32 v18, 0, v18
    v_ashrrev_i32 v19, 31, v18
    v_or_b32 v19, 0x80000000, v19
    v_xor_b32 v18, v18, v19
    v_and_b32 v18, 0xffff0000, v18
    v_or_b32 v18, s7, v18
    s_mov_b32 exec_lo, 0
    s_mov_b32 exec_hi, 0x80000000
    ds_write_b32 v28, v18 offset:35856
    ds_add_rtn_u32 v19, v22, v29 offset:35888
    s_mov_b64 exec, -1
    v_readlane_b32 s12, v16, 63
    v_readlane_b32 s13, v17, 63
    s_lshl_b32 s8, s4, 7
    s_add_u32 s8, s8, 524288
    s_waitcnt lgkmcnt(0)
    v_readlane_b32 s14, v19, 63
    s_nop 1
    s_cmp_lg_u32 s14, 7
    s_cbranch_scc1 K3_NK
    s_mov_b64 exec, 3
    ds_read_b128 v[8:11], v5 offset:35856
    s_waitcnt lgkmcnt(0)
    buffer_store_dwordx4 v[8:11], v5, s[44:47], s8 offen sc1
    s_mov_b64 exec, -1
K3_NK:
    s_setprio 0
    v_pk_add_f32 v[104:105], v[84:85], s[12:13] op_sel_hi:[1,0] neg_lo:[0,1] neg_hi:[0,1]
    v_pk_add_f32 v[106:107], v[86:87], s[12:13] op_sel_hi:[1,0] neg_lo:[0,1] neg_hi:[0,1]
    v_pk_add_f32 v[108:109], v[88:89], s[12:13] op_sel_hi:[1,0] neg_lo:[0,1] neg_hi:[0,1]
    v_pk_add_f32 v[110:111], v[90:91], s[12:13] op_sel_hi:[1,0] neg_lo:[0,1] neg_hi:[0,1]
    v_pk_add_f32 v[112:113], v[92:93], s[12:13] op_sel_hi:[1,0] neg_lo:[0,1] neg_hi:[0,1]
    v_cvt_pk_bf16_f32 v104, 0, v104
    v_cvt_pk_bf16_f32 v105, 0, v105
    v_cvt_pk_bf16_f32 v106, 0, v106
    v_cvt_pk_bf16_f32 v107, 0, v107
    v_cvt_pk_bf16_f32 v108, 0, v108
    v_cvt_pk_bf16_f32 v109, 0, v109
    v_cvt_pk_bf16_f32 v110, 0, v110
    v_cvt_pk_bf16_f32 v111, 0, v111
    v_cvt_pk_bf16_f32 v112, 0, v112
    v_cvt_pk_bf16_f32 v113, 0, v113
    v_pk_mul_f32 v[104:105], v[104:105], s[12:13] op_sel:[0,1] op_sel_hi:[1,1]
    v_pk_mul_f32 v[106:107], v[106:107], s[12:13] op_sel:[0,1] op_sel_hi:[1,1]
    v_pk_mul_f32 v[108:109], v[108:109], s[12:13] op_sel:[0,1] op_sel_hi:[1,1]
    v_pk_mul_f32 v[110:111], v[110:111], s[12:13] op_sel:[0,1] op_sel_hi:[1,1]
    v_pk_mul_f32 v[112:113], v[112:113], s[12:13] op_sel:[0,1] op_sel_hi:[1,1]
    v_cvt_pk_bf16_f32 v104, 0, v104
    v_cvt_pk_bf16_f32 v105, 0, v105
    v_cvt_pk_bf16_f32 v106, 0, v106
    v_cvt_pk_bf16_f32 v107, 0, v107
    v_cvt_pk_bf16_f32 v108, 0, v108
    v_cvt_pk_bf16_f32 v109, 0, v109
    v_cvt_pk_bf16_f32 v110, 0, v110
    v_cvt_pk_bf16_f32 v111, 0, v111
    v_cvt_pk_bf16_f32 v112, 0, v112
    v_cvt_pk_bf16_f32 v113, 0, v113
    v_pk_mul_f32 v[104:105], v[104:105], v[62:63]
    v_pk_mul_f32 v[106:107], v[106:107], v[64:65]
    v_pk_mul_f32 v[108:109], v[108:109], v[66:67]
    v_pk_mul_f32 v[110:111], v[110:111], v[68:69]
    v_pk_mul_f32 v[112:113], v[112:113], v[70:71]
    v_cvt_pk_bf16_f32 v104, 0, v104
    v_cvt_pk_bf16_f32 v105, 0, v105
    v_cvt_pk_bf16_f32 v106, 0, v106
    v_cvt_pk_bf16_f32 v107, 0, v107
    v_cvt_pk_bf16_f32 v108, 0, v108
    v_cvt_pk_bf16_f32 v109, 0, v109
    v_cvt_pk_bf16_f32 v110, 0, v110
    v_cvt_pk_bf16_f32 v111, 0, v111
    v_cvt_pk_bf16_f32 v112, 0, v112
    v_cvt_pk_bf16_f32 v113, 0, v113
    v_pk_add_f32 v[104:105], v[104:105], v[72:73]
    v_pk_add_f32 v[106:107], v[106:107], v[74:75]
    v_pk_add_f32 v[108:109], v[108:109], v[76:77]
    v_pk_add_f32 v[110:111], v[110:111], v[78:79]
    v_pk_add_f32 v[112:113], v[112:113], v[80:81]
    v_cvt_pk_bf16_f32 v52, v104, v105
    v_cvt_pk_bf16_f32 v53, v106, v107
    v_cvt_pk_bf16_f32 v54, v108, v109
    v_cvt_pk_bf16_f32 v56, v110, v111
    v_cvt_pk_bf16_f32 v57, v112, v113
    v_mov_b32 v47, s1
    v_mov_b32 v51, s1
    v_mov_b32 v55, s1
    v_mov_b32 v59, s1
    v_lshlrev_b32 v104, 16, v52
    v_and_b32 v105, 0xffff0000, v52
    v_lshlrev_b32 v106, 16, v53
    v_and_b32 v107, 0xffff0000, v53
    v_lshlrev_b32 v108, 16, v54
    v_and_b32 v109, 0xffff0000, v54
    v_lshlrev_b32 v110, 16, v56
    v_and_b32 v111, 0xffff0000, v56
    v_lshlrev_b32 v112, 16, v57
    v_and_b32 v113, 0xffff0000, v57
    s_lshl_b32 s7, s5, 12
    s_add_u32 s7, s7, 16777216
    s_lshr_b32 s63, s63, 31
    s_cbranch_scc0 K3_NC
    buffer_store_dwordx4 v[52:55], v5, s[44:47], s7 offen offset:0 sc1
    buffer_store_dwordx4 v[56:59], v5, s[44:47], s7 offen offset:1024 sc1
    buffer_store_dwordx4 v[44:47], v5, s[44:47], s7 offen offset:2048 sc1
    buffer_store_dwordx4 v[48:51], v5, s[44:47], s7 offen offset:3072 sc1
K3_NC:
    v_pk_mul_f32 v[104:105], v[104:105], v[94:95]
    v_pk_mul_f32 v[106:107], v[106:107], v[96:97]
    v_pk_mul_f32 v[108:109], v[108:109], v[98:99]
    v_pk_mul_f32 v[110:111], v[110:111], v[100:101]
    v_pk_mul_f32 v[112:113], v[112:113], v[102:103]
    v_cvt_pk_bf16_f32 v104, 0, v104
    v_cvt_pk_bf16_f32 v105, 0, v105
    v_cvt_pk_bf16_f32 v106, 0, v106
    v_cvt_pk_bf16_f32 v107, 0, v107
    v_cvt_pk_bf16_f32 v108, 0, v108
    v_cvt_pk_bf16_f32 v109, 0, v109
    v_cvt_pk_bf16_f32 v110, 0, v110
    v_cvt_pk_bf16_f32 v111, 0, v111
    v_cvt_pk_bf16_f32 v112, 0, v112
    v_cvt_pk_bf16_f32 v113, 0, v113
    v_pk_add_f32 v[104:105], v[104:105], v[84:85]
    v_pk_add_f32 v[106:107], v[106:107], v[86:87]
    v_pk_add_f32 v[108:109], v[108:109], v[88:89]
    v_pk_add_f32 v[110:111], v[110:111], v[90:91]
    v_pk_add_f32 v[112:113], v[112:113], v[92:93]
    v_cvt_pk_bf16_f32 v116, v104, v105
    v_cvt_pk_bf16_f32 v117, v106, v107
    v_cvt_pk_bf16_f32 v118, v108, v109
    v_cvt_pk_bf16_f32 v119, v110, v111
    v_cvt_pk_bf16_f32 v120, v112, v113
    s_cmp_lg_u32 s63, 0
    s_cbranch_scc1 K3_NO
    buffer_store_dwordx4 v[116:119], v5, s[64:67], s6 offen sc1
    v_mov_b32 v24, v120
    v_mov_b32_dpp v25, v120 quad_perm:[1,1,1,1] row_mask:0xf bank_mask:0xf
    v_mov_b32_dpp v26, v120 quad_perm:[2,2,2,2] row_mask:0xf bank_mask:0xf
    v_mov_b32_dpp v27, v120 quad_perm:[3,3,3,3] row_mask:0xf bank_mask:0xf
    s_mov_b32 exec_lo, 0x11111111
    s_mov_b32 exec_hi, 0x11111111
    buffer_store_dwordx4 v[24:27], v35, s[64:67], s6 offen offset:1024 sc1
    s_mov_b64 exec, -1
K3_NO:
    v_readlane_b32 s9, v18, 63
    s_sub_u32 s10, 2047, s5
    s_nop 0
    s_and_b32 s9, s9, 0xffff0000
    s_or_b32 s9, s9, s10
    s_cmp_lg_u32 s14, 7
    s_cbranch_scc1 K3_SW
    s_lshl_b32 s8, s4, 7
    s_add_u32 s8, s8, 589824
    s_mov_b64 exec, 1
    s_sleep 40
SLW_NS:
    s_mov_b32 s15, 65536
SLW_LOOP:
    s_sleep 8
    buffer_load_dwordx2 v[8:9], v5, s[44:47], s8 offen sc1
    s_waitcnt vmcnt(0)
    v_cmp_ne_u32 vcc, s1, v9
    s_sub_u32 s15, s15, 1
    s_cbranch_scc1 SLW_DONE
    s_cbranch_vccz SLW_DONE
    s_branch SLW_LOOP
SLW_DONE:
    ds_write_b32 v5, v8 offset:35852
    s_mov_b64 exec, -1
    s_waitcnt lgkmcnt(0)
K3_SW:
    s_barrier
    ds_read_b32 v8, v22 offset:35852
    s_waitcnt lgkmcnt(0)
    v_readfirstlane_b32 s10, v8
    s_nop 1
    s_cmp_ge_u32 s9, s10
    s_cselect_b32 s10, 1, 0
    s_cmp_eq_u32 s10, s63
    s_cbranch_scc1 KM_END
    s_cmp_eq_u32 s63, 0
    s_cbranch_scc1 K3_LATE
    buffer_store_dwordx4 v[116:119], v5, s[64:67], s6 offen sc1
    v_mov_b32 v24, v120
    v_mov_b32_dpp v25, v120 quad_perm:[1,1,1,1] row_mask:0xf bank_mask:0xf
    v_mov_b32_dpp v26, v120 quad_perm:[2,2,2,2] row_mask:0xf bank_mask:0xf
    v_mov_b32_dpp v27, v120 quad_perm:[3,3,3,3] row_mask:0xf bank_mask:0xf
    s_mov_b32 exec_lo, 0x11111111
    s_mov_b32 exec_hi, 0x11111111
    buffer_store_dwordx4 v[24:27], v35, s[64:67], s6 offen offset:1024 sc1
    s_mov_b64 exec, -1
    s_branch KM_END
K3_LATE:
    s_waitcnt vmcnt(0)
    buffer_store_dwordx4 v[52:55], v5, s[44:47], s7 offen offset:0 sc1
    buffer_store_dwordx4 v[56:59], v5, s[44:47], s7 offen offset:1024 sc1
    buffer_store_dwordx4 v[44:47], v5, s[44:47], s7 offen offset:2048 sc1
    buffer_store_dwordx4 v[48:51], v5, s[44:47], s7 offen offset:3072 sc1
    s_branch KM_END
HELPER:
    s_sub_u32 s42, s2, 256
    s_waitcnt lgkmcnt(0)
    s_mov_b32 s44, s40
    s_mov_b32 s45, s41
    s_mov_b32 s46, 0x4000000
    s_mov_b32 s47, 0x20000
    s_load_dword s1, s[40:41], 0x30000
    v_mov_b32 v16, 0
    s_cmp_ge_u32 s42, 160
    s_cbranch_scc1 H_NP
    s_mov_b32 s48, s18
    s_mov_b32 s49, s19
    s_mov_b32 s50, 0x141000
    s_mov_b32 s51, 0x20000
    s_mov_b32 s52, s20
    s_mov_b32 s53, s21
    s_mov_b32 s54, 0x141000
    s_mov_b32 s55, 0x20000
    s_and_b32 s4, s42, 7
    s_lshr_b32 s5, s42, 3
    s_and_b32 s6, s5, 3
    s_lshr_b32 s5, s5, 2
    s_cmp_lt_u32 s4, 2
    s_cbranch_scc1 HP_Q0
    s_lshr_b32 s7, s4, 1
    s_sub_u32 s8, 8, s7
    s_bitcmp1_b32 s4, 0
    s_cselect_b32 s7, s8, s7
    s_cselect_b32 s9, 255, 0
    s_cselect_b32 s10, 0x80008000, 0
    s_branch HP_GO
HP_Q0:
    s_lshr_b32 s7, s5, 1
    s_lshl_b32 s7, s7, 2
    s_mul_i32 s8, s4, 3
    s_and_b32 s9, s5, 1
    s_add_u32 s8, s8, s9
    s_lshl_b32 s9, s4, 2
    s_cmp_eq_u32 s5, 4
    s_cselect_b32 s7, s9, s7
    s_cselect_b32 s5, 2, s8
    s_mov_b32 s9, 0
    s_mov_b32 s10, 0
HP_GO:
    s_lshl_b32 s5, s5, 6
    s_and_b32 s8, s7, 1
    s_add_u32 s5, s5, s8
    v_and_b32 v3, 7, v1
    v_lshrrev_b32 v4, 3, v1
    v_and_b32 v5, 3, v4
    v_lshrrev_b32 v4, 2, v4
    s_lshl_b32 s8, s3, 1
    v_add_u32 v4, s8, v4
    s_lshl_b32 s12, s6, 6
    v_lshl_add_u32 v6, v5, 4, v4
    v_add_u32 v6, s12, v6
    v_xor_b32 v6, s9, v6
    s_movk_i32 s12, 5136
    v_mul_u32_u24 v6, s12, v6
    v_lshl_add_u32 v6, v3, 4, v6
    s_mul_i32 s12, s7, 642
    s_lshl_b32 s13, s5, 1
    s_add_u32 s12, s12, s13
    buffer_load_dwordx4 v[8:11], v6, s[48:51], s12 offen nt
    buffer_load_dwordx4 v[12:15], v6, s[52:55], s12 offen nt
    v_lshlrev_b32 v6, 1, v3
    v_xor_b32 v7, v6, v4
    v_lshlrev_b32 v5, 2, v5
    v_lshl_add_u32 v5, v3, 11, v5
    v_lshl_add_u32 v7, v7, 4, v5
    v_and_b32 v3, 15, v1
    v_xor_b32 v4, s8, v3
    v_lshrrev_b32 v5, 4, v1
    v_lshlrev_b32 v4, 4, v4
    v_lshl_add_u32 v4, v5, 8, v4
    s_lshl_b32 s11, s3, 11
    v_add_u32 v4, s11, v4
    v_lshlrev_b32 v3, 4, v3
    v_lshl_add_u32 v3, v5, 10, v3
    s_mul_i32 s11, s7, 321
    s_add_u32 s11, s11, s5
    s_lshl_b32 s12, s3, 3
    s_add_u32 s11, s11, s12
    s_lshl_b32 s11, s11, 10
    s_lshl_b32 s12, s6, 8
    s_add_u32 s11, s11, s12
    s_add_u32 s11, s11, 9437184
    s_mov_b32 s12, 0x05040100
    s_mov_b32 s13, 0x07060302
    s_mov_b32 s14, 0x7fff7fff
    s_mov_b32 s60, s10
    s_mov_b32 s61, s11
    s_and_b32 s7, s42, 7
    s_lshr_b32 s8, s42, 3
    s_mov_b64 s[74:75], 0
    s_mov_b32 s67, 0x20000
    s_mov_b32 s66, 0x21c000
    s_cmp_lt_u32 s7, 3
    s_cselect_b32 s9, 16, 12
    s_cselect_b32 s99, 0, 2
    s_cmp_lt_u32 s8, s9
    s_cselect_b32 s99, 1, s99
    s_cbranch_scc1 HR_4
    s_sub_u32 s8, s8, 12
    s_lshr_b32 s9, s8, 3
    s_mul_i32 s9, s9, 5
    s_add_u32 s9, s9, s7
    s_sub_u32 s9, s9, 3
    s_and_b32 s8, s8, 7
    s_lshl_b32 s10, s9, 6
    s_lshl_b32 s11, s8, 3
    s_add_u32 s43, s10, s11
    s_mov_b32 s64, s30
    s_mov_b32 s65, s31
    s_movk_i32 s10, 1280
    s_mul_i32 s68, s8, 276480
    s_lshl_b32 s9, s9, 7
    s_add_u32 s68, s68, s9
    s_mul_i32 s12, s3, 34560
    s_add_u32 s68, s68, s12
    s_cmp_eq_u32 s99, 2
    s_cselect_b32 s74, 0x7ffffff, 0
    s_branch HR_D
HR_4:
    s_lshr_b32 s9, s8, 2
    s_lshl_b32 s9, s9, 3
    s_add_u32 s9, s9, s7
    s_and_b32 s8, s8, 3
    s_lshl_b32 s10, s9, 2
    s_add_u32 s43, s10, s8
    s_cmp_ge_u32 s3, 4
    s_cselect_b32 s64, s28, s26
    s_cselect_b32 s65, s29, s27
    s_movk_i32 s10, 3456
    s_mul_i32 s68, s8, 552960
    s_lshl_b32 s9, s9, 7
    s_add_u32 s68, s68, s9
    s_and_b32 s11, s3, 3
    s_mul_i32 s11, s11, 138240
    s_add_u32 s68, s68, s11
    s_mov_b32 s74, -1
    s_mov_b32 s75, 0xff
HR_D:
    v_mul_u32_u24 v34, s10, v1
    s_mov_b32 s10, s60
    s_mov_b32 s11, s61
    s_mov_b32 s12, 0x05040100
    s_waitcnt vmcnt(0)
HP_W:
    v_xor_b32 v16, s10, v12
    v_perm_b32 v24, v16, v8, s12
    v_perm_b32 v25, v16, v8, s13
    ds_write2st64_b32 v7, v24, v25 offset0:0 offset1:1
    v_xor_b32 v17, s10, v13
    v_perm_b32 v26, v17, v9, s12
    v_perm_b32 v27, v17, v9, s13
    ds_write2st64_b32 v7, v26, v27 offset0:2 offset1:3
    v_xor_b32 v18, s10, v14
    v_perm_b32 v28, v18, v10, s12
    v_perm_b32 v29, v18, v10, s13
    ds_write2st64_b32 v7, v28, v29 offset0:4 offset1:5
    v_xor_b32 v19, s10, v15
    v_perm_b32 v30, v19, v11, s12
    v_perm_b32 v31, v19, v11, s13
    ds_write2st64_b32 v7, v30, v31 offset0:6 offset1:7
    v_and_b32 v8, s14, v8
    v_and_b32 v9, s14, v9
    v_and_b32 v10, s14, v10
    v_and_b32 v11, s14, v11
    v_and_b32 v12, s14, v12
    v_and_b32 v13, s14, v13
    v_and_b32 v14, s14, v14
    v_and_b32 v15, s14, v15
    v_pk_max_u16 v8, v8, v12
    v_pk_max_u16 v9, v9, v13
    v_pk_max_u16 v10, v10, v14
    v_pk_max_u16 v11, v11, v15
    v_pk_max_u16 v8, v8, v10
    v_pk_max_u16 v9, v9, v11
    v_pk_max_u16 v40, v8, v9
    v_lshrrev_b32 v41, 16, v40
    v_and_b32 v40, 0xffff, v40
    v_max_u32 v40, v40, v41
    s_nop 1
    v_max_u32_dpp v40, v40, v40 row_ror:8 row_mask:0xf bank_mask:0xf
    s_nop 1
    v_max_u32_dpp v40, v40, v40 row_ror:4 row_mask:0xf bank_mask:0xf
    s_nop 1
    v_max_u32_dpp v40, v40, v40 row_ror:2 row_mask:0xf bank_mask:0xf
    s_nop 1
    v_max_u32_dpp v40, v40, v40 row_ror:1 row_mask:0xf bank_mask:0xf
    s_nop 1
    v_max_u32_dpp v40, v40, v40 row_bcast:15 row_mask:0xa bank_mask:0xf
    s_nop 1
    v_max_u32_dpp v40, v40, v40 row_bcast:31 row_mask:0xc bank_mask:0xf
    v_mov_b32 v41, 16384
    v_readlane_b32 s4, v40, 63
    s_lshl_b32 s12, s3, 2
    s_nop 0
    v_mov_b32 v40, s4
    v_add_u32 v41, s12, v41
    ds_write_b32 v41, v40
    s_waitcnt lgkmcnt(0)
    s_barrier
    ds_read_b128 v[8:11], v4 offset:0
    ds_read_b128 v[12:15], v4 offset:1024
    v_mov_b32 v41, 16384
    ds_read_b128 v[16:19], v41
    ds_read_b128 v[20:23], v41 offset:16
    s_add_u32 s12, s11, 4096
    s_waitcnt lgkmcnt(3)
    buffer_store_dwordx4 v[8:11], v3, s[44:47], s11 offen sc1
    s_waitcnt lgkmcnt(2)
    buffer_store_dwordx4 v[12:15], v3, s[44:47], s12 offen sc1
    s_waitcnt lgkmcnt(0)
    v_max3_u32 v16, v16, v17, v18
    v_max3_u32 v20, v20, v21, v22
    v_max3_u32 v16, v16, v19, v23
    v_max_u32 v16, v16, v20
    s_branch H_FA
H_NP:
    s_cmp_ge_u32 s42, 200
    s_cbranch_scc1 H_NS
    s_cmp_lg_u32 s3, 0
    s_cbranch_scc1 H_NS1
    s_sub_u32 s15, s42, 160
    s_mov_b32 s48, s18
    s_mov_b32 s49, s19
    s_mov_b32 s50, 0x141000
    s_mov_b32 s51, 0x20000
    s_mov_b32 s52, s20
    s_mov_b32 s53, s21
    s_mov_b32 s54, 0x141000
    s_mov_b32 s55, 0x20000
    s_lshr_b32 s6, s15, 2
    s_and_b32 s7, s15, 3
    s_cmp_ge_u32 s6, 5
    s_cselect_b32 s4, 640, 0
    s_cselect_b32 s8, 5, 0
    s_sub_u32 s8, s6, s8
    s_lshl_b32 s9, s7, 7
    s_add_u32 s8, s8, s9
    v_and_b32 v3, 15, v1
    v_lshrrev_b32 v4, 4, v1
    v_lshl_add_u32 v3, v4, 6, v3
    v_lshl_add_u32 v4, v3, 3, s8
    s_movk_i32 s5, 642
    v_sub_u32 v5, 2048, v4
    v_and_b32 v5, 2047, v5
    v_mul_u32_u24 v4, s5, v4
    v_mul_u32_u24 v5, s5, v5
    buffer_load_ushort v8, v4, s[48:51], s4 offen
    buffer_load_ushort v9, v4, s[52:55], s4 offen
    buffer_load_ushort v10, v5, s[48:51], s4 offen
    buffer_load_ushort v11, v5, s[52:55], s4 offen
    s_lshl_b32 s5, s6, 11
    s_lshl_b32 s7, s7, 2
    s_add_u32 s5, s5, s7
    s_add_u32 s5, s5, 131072
    v_lshlrev_b32 v3, 5, v1
    s_waitcnt vmcnt(0)
    v_and_b32 v12, 0x7fff, v8
    v_and_b32 v13, 0x7fff, v9
    v_and_b32 v14, 0x7fff, v10
    v_and_b32 v15, 0x7fff, v11
    v_lshlrev_b32 v8, 16, v8
    v_lshlrev_b32 v9, 16, v9
    v_lshlrev_b32 v10, 16, v10
    v_lshlrev_b32 v11, 16, v11
    v_max3_u32 v6, v12, v13, v14
    v_max_u32 v6, v6, v15
    v_mul_f32 v8, 0.5, v8
    v_mul_f32 v9, 0.5, v9
    v_fmac_f32 v8, 0.5, v10
    v_fmac_f32 v9, -0.5, v11
    buffer_store_dword v8, v3, s[44:47], s5 offen sc1
    buffer_store_dword v9, v3, s[44:47], s5 offen offset:16 sc1
    v_max_u32_dpp v6, v6, v6 row_ror:8 row_mask:0xf bank_mask:0xf
    s_nop 1
    v_max_u32_dpp v6, v6, v6 row_ror:4 row_mask:0xf bank_mask:0xf
    s_nop 1
    v_max_u32_dpp v6, v6, v6 row_ror:2 row_mask:0xf bank_mask:0xf
    s_nop 1
    v_max_u32_dpp v6, v6, v6 row_ror:1 row_mask:0xf bank_mask:0xf
    s_nop 1
    v_max_u32_dpp v6, v6, v6 row_bcast:15 row_mask:0xa bank_mask:0xf
    s_nop 1
    v_max_u32_dpp v6, v6, v6 row_bcast:31 row_mask:0xc bank_mask:0xf
    s_nop 0
    v_readlane_b32 s6, v6, 63
    s_nop 1
    v_mov_b32 v16, s6
    s_branch H_NS
H_NS1:
H_NS:
    s_and_b32 s7, s42, 7
    s_lshr_b32 s8, s42, 3
    s_mov_b64 s[74:75], 0
    s_mov_b32 s67, 0x20000
    s_mov_b32 s66, 0x21c000
    s_cmp_lt_u32 s7, 3
    s_cselect_b32 s9, 16, 12
    s_cselect_b32 s99, 0, 2
    s_cmp_lt_u32 s8, s9
    s_cselect_b32 s99, 1, s99
    s_cbranch_scc1 HRb_4
    s_sub_u32 s8, s8, 12
    s_lshr_b32 s9, s8, 3
    s_mul_i32 s9, s9, 5
    s_add_u32 s9, s9, s7
    s_sub_u32 s9, s9, 3
    s_and_b32 s8, s8, 7
    s_lshl_b32 s10, s9, 6
    s_lshl_b32 s11, s8, 3
    s_add_u32 s43, s10, s11
    s_mov_b32 s64, s30
    s_mov_b32 s65, s31
    s_movk_i32 s10, 1280
    s_mul_i32 s68, s8, 276480
    s_lshl_b32 s9, s9, 7
    s_add_u32 s68, s68, s9
    s_mul_i32 s12, s3, 34560
    s_add_u32 s68, s68, s12
    s_cmp_eq_u32 s99, 2
    s_cselect_b32 s74, 0x7ffffff, 0
    s_branch HRb_D
HRb_4:
    s_lshr_b32 s9, s8, 2
    s_lshl_b32 s9, s9, 3
    s_add_u32 s9, s9, s7
    s_and_b32 s8, s8, 3
    s_lshl_b32 s10, s9, 2
    s_add_u32 s43, s10, s8
    s_cmp_ge_u32 s3, 4
    s_cselect_b32 s64, s28, s26
    s_cselect_b32 s65, s29, s27
    s_movk_i32 s10, 3456
    s_mul_i32 s68, s8, 552960
    s_lshl_b32 s9, s9, 7
    s_add_u32 s68, s68, s9
    s_and_b32 s11, s3, 3
    s_mul_i32 s11, s11, 138240
    s_add_u32 s68, s68, s11
    s_mov_b32 s74, -1
    s_mov_b32 s75, 0xff
HRb_D:
    v_mul_u32_u24 v34, s10, v1
H_FA:
    s_waitcnt lgkmcnt(0)
    s_add_u32 s1, s1, 1
    s_cmp_ge_u32 s42, 200
    s_cbranch_scc1 H_FB
    s_waitcnt vmcnt(0) lgkmcnt(0)
    s_barrier
H_FB:
    s_cmp_lg_u32 s3, 0
    s_cbranch_scc1 H_JB
    v_mov_b32 v17, s1
    v_lshlrev_b32 v3, 11, v1
    s_lshl_b32 s4, s42, 3
    s_add_u32 s4, s4, 200704
    s_mov_b64 exec, 0xff
    buffer_store_dwordx2 v[16:17], v3, s[44:47], s4 offen sc1
    s_mov_b64 exec, 1
    ds_write_b32 v3, v3 offset:8512
    s_mov_b64 exec, -1
H_JB:
    s_cmp_ge_u32 s42, 200
    s_cbranch_scc1 H_JC
    s_cmp_lg_u32 s3, 1
    s_cbranch_scc1 H_JC
    s_cmp_lt_u32 s42, 160
    s_cbranch_scc1 H_JC
    s_sub_u32 s15, s42, 160
    v_lshlrev_b32 v6, 4, v1
    s_bfe_u32 s8, s1, 0x80000
    s_bfe_u32 s9, s1, 0x80008
    s_bfe_u32 s10, s1, 0x80010
    s_bfe_u32 s11, s1, 0x80018
    v_mov_b32 v28, s8
    v_mov_b32 v29, s9
    v_mov_b32 v30, s10
    v_mov_b32 v31, s11
    s_mov_b64 exec, 0xffff
    s_lshl_b32 s5, s15, 8
    s_add_u32 s4, s5, 278528
    s_add_u32 s12, s4, 10240
    s_add_u32 s13, s4, 20480
    s_add_u32 s60, s4, 30720
    s_add_u32 s61, s4, 40960
    s_sleep 24
GBR_NS:
    s_mov_b32 s14, 65536
GBR_LOOP:
    buffer_load_dwordx4 v[48:51], v6, s[44:47], s4 offen sc1
    buffer_load_dwordx4 v[52:55], v6, s[44:47], s12 offen sc1
    buffer_load_dwordx4 v[56:59], v6, s[44:47], s13 offen sc1
    buffer_load_dwordx4 v[60:63], v6, s[44:47], s60 offen sc1
    buffer_load_dwordx4 v[64:67], v6, s[44:47], s61 offen sc1
    s_waitcnt vmcnt(0)
    v_xor_b32 v48, v28, v48
    v_xor_b32 v49, v29, v49
    v_xor_b32 v50, v30, v50
    v_xor_b32 v51, v31, v51
    v_xor_b32 v52, v28, v52
    v_xor_b32 v53, v29, v53
    v_xor_b32 v54, v30, v54
    v_xor_b32 v55, v31, v55
    v_xor_b32 v56, v28, v56
    v_xor_b32 v57, v29, v57
    v_xor_b32 v58, v30, v58
    v_xor_b32 v59, v31, v59
    v_xor_b32 v60, v28, v60
    v_xor_b32 v61, v29, v61
    v_xor_b32 v62, v30, v62
    v_xor_b32 v63, v31, v63
    v_xor_b32 v64, v28, v64
    v_xor_b32 v65, v29, v65
    v_xor_b32 v66, v30, v66
    v_xor_b32 v67, v31, v67
    v_or3_b32 v8, v48, v49, v50
    v_or3_b32 v9, v51, v52, v53
    v_or3_b32 v10, v54, v55, v56
    v_or3_b32 v11, v57, v58, v59
    v_or3_b32 v12, v60, v61, v62
    v_or3_b32 v13, v63, v64, v65
    v_or3_b32 v8, v8, v9, v10
    v_or3_b32 v11, v11, v12, v13
    v_or3_b32 v8, v8, v66, v67
    v_or_b32 v8, v8, v11
    v_and_b32 v8, 255, v8
    v_cmp_ne_u32 vcc, 0, v8
    s_sub_u32 s14, s14, 1
    s_cbranch_scc1 GBR_DONE
    s_cbranch_vccz GBR_DONE
    s_mov_b64 exec, vcc
    s_branch GBR_LOOP
GBR_DONE:
    s_mov_b64 exec, 0xffff
    v_pk_add_f32 v[48:49], v[48:49], v[52:53]
    v_pk_add_f32 v[56:57], v[56:57], v[60:61]
    v_pk_add_f32 v[50:51], v[50:51], v[54:55]
    v_pk_add_f32 v[58:59], v[58:59], v[62:63]
    v_pk_add_f32 v[48:49], v[48:49], v[64:65]
    v_pk_add_f32 v[50:51], v[50:51], v[66:67]
    v_pk_add_f32 v[40:41], v[48:49], v[56:57]
    v_pk_add_f32 v[42:43], v[50:51], v[58:59]
    s_add_u32 s5, s5, 262144
    s_lshr_b32 s8, s1, 16
    s_and_b32 s7, s1, 0xffff
    s_sub_u32 s9, s15, 20
    s_cmp_lt_u32 s9, 10
    s_cselect_b32 s10, 1.0, 0
    v_cvt_pk_bf16_f32 v40, 0, v40
    v_cvt_pk_bf16_f32 v41, 0, v41
    v_cvt_pk_bf16_f32 v42, 0, v42
    v_cvt_pk_bf16_f32 v43, 0, v43
    v_add_f32 v40, s10, v40
    v_add_f32 v41, s10, v41
    v_add_f32 v42, s10, v42
    v_add_f32 v43, s10, v43
    v_cvt_pk_bf16_f32 v40, 0, v40
    v_cvt_pk_bf16_f32 v41, 0, v41
    v_cvt_pk_bf16_f32 v42, 0, v42
    v_cvt_pk_bf16_f32 v43, 0, v43
    v_or_b32 v40, s7, v40
    v_or_b32 v41, s8, v41
    v_or_b32 v42, s7, v42
    v_or_b32 v43, s8, v43
    buffer_store_dwordx4 v[40:43], v6, s[44:47], s5 offen sc1
    s_mov_b64 exec, -1
H_JC:
    s_cmp_eq_u32 s99, 0
    s_cbranch_scc1 KM_END
    v_lshlrev_b32 v5, 4, v1
    v_lshlrev_b32 v35, 2, v1
    v_lshlrev_b32 v36, 3, v1
    v_and_b32 v2, 15, v1
    v_lshrrev_b32 v3, 4, v1
    s_cmp_lg_u32 s3, 0
    s_cbranch_scc1 H_GOW
    s_lshl_b32 s8, s42, 7
    s_add_u32 s8, s8, 622592
    s_and_b32 s9, s42, 7
    s_lshl_b32 s9, s9, 5
    s_lshr_b32 s10, s42, 3
    s_add_u32 s9, s9, s10
    s_lshl_b32 s9, s9, 7
    s_add_u32 s9, s9, 524288
    s_cmp_eq_u32 s99, 2
    s_cselect_b32 s8, s9, s8
    s_and_b32 s9, s1, 0xffff
    s_mov_b64 exec, 1
    s_sleep 32
GOG_NS:
    s_mov_b32 s15, 65536
GOG_LOOP:
    s_sleep 4
    buffer_load_dword v8, v5, s[44:47], s8 offen sc1
    s_waitcnt vmcnt(0)
    v_and_b32 v8, 0xffff, v8
    v_cmp_ne_u32 vcc, s9, v8
    s_sub_u32 s15, s15, 1
    s_cbranch_scc1 GOG_DONE
    s_cbranch_vccz GOG_DONE
    s_branch GOG_LOOP
GOG_DONE:
    s_mov_b64 exec, -1
    s_cmp_eq_u32 s99, 2
    s_cbranch_scc1 H_GOW
    s_sleep 4
H_GOW:
    s_barrier
    s_cmp_lg_u32 s99, 2
    s_cbranch_scc1 H_G4
    s_lshl_b32 s11, s43, 1
    s_mul_i32 s12, s3, 81920
    s_add_u32 s11, s11, s12
    s_lshl_b32 s12, s3, 10
    s_add_u32 s12, s12, 20480
    s_mov_b32 m0, s12
    s_nop 0
    buffer_load_dwordx4 v34, s[64:67], s11 offen lds
    s_add_u32 s12, s12, 8192
    s_add_u32 s11, s11, 655360
    s_mov_b32 m0, s12
    s_nop 0
    buffer_load_dwordx4 v34, s[64:67], s11 offen lds
    s_add_u32 s12, s12, 8192
    s_add_u32 s11, s11, 655360
    s_mov_b32 m0, s12
    s_nop 0
    buffer_load_dwordx4 v34, s[64:67], s11 offen lds
    s_add_u32 s12, s12, 8192
    s_add_u32 s11, s11, 655360
    s_mov_b32 m0, s12
    s_nop 0
    buffer_load_dwordx4 v34, s[64:67], s11 offen lds
    s_waitcnt vmcnt(0)
    s_lshl_b32 s12, s3, 10
    s_add_u32 s12, s12, 20480
    v_lshrrev_b32 v14, 2, v2
    v_lshl_add_u32 v14, v3, 3, v14
    v_lshlrev_b32 v14, 4, v14
    v_and_b32 v15, 1, v2
    v_lshl_add_u32 v14, v15, 3, v14
    v_bfe_u32 v15, v2, 1, 1
    v_lshl_add_u32 v14, v15, 9, v14
    v_add_u32 v14, s12, v14
    ds_read_b64_tr_b16 v[104:105], v14 offset:0
    ds_read_b64_tr_b16 v[106:107], v14 offset:64
    ds_read_b64_tr_b16 v[108:109], v14 offset:8192
    ds_read_b64_tr_b16 v[110:111], v14 offset:8256
    ds_read_b64_tr_b16 v[112:113], v14 offset:16384
    ds_read_b64_tr_b16 v[114:115], v14 offset:16448
    ds_read_b64_tr_b16 v[116:117], v14 offset:24576
    ds_read_b64_tr_b16 v[118:119], v14 offset:24640
    s_branch H_SEL
H_G4:
    s_movk_i32 s10, 3456
    v_lshrrev_b32 v7, 1, v1
    v_mul_u32_u24 v4, s10, v7
    v_and_b32 v7, 1, v1
    v_lshl_add_u32 v4, v7, 4, v4
    s_and_b32 s13, s3, 3
    s_mul_i32 s11, s13, 442368
    s_mul_i32 s13, s13, 110592
    s_lshl_b32 s12, s43, 5
    s_add_u32 s11, s11, s12
    s_add_u32 s13, s13, s12
    s_add_u32 s13, s13, 1769472
    s_mul_i32 s12, s3, 5120
    s_add_u32 s12, s12, 20480
    v_lshrrev_b32 v9, 2, v2
    v_lshlrev_b32 v9, 5, v9
    v_and_b32 v7, 3, v2
    v_lshl_add_u32 v9, v7, 3, v9
    s_and_b32 s14, s3, 3
    s_mul_i32 s14, s14, 5120
    s_add_u32 s14, s14, 20480
    v_add_u32 v9, s14, v9
    v_lshrrev_b32 v8, 3, v2
    s_movk_i32 s14, 192
    v_mad_u32_u24 v7, v8, s14, v9
    v_lshl_add_u32 v7, v3, 6, v7
    v_lshl_add_u32 v9, v3, 8, v9
    s_lshr_b32 s14, s3, 2
    s_lshl_b32 s14, s14, 9
    v_add_u32 v7, s14, v7
    v_lshl_add_u32 v9, s14, 2, v9
    s_waitcnt vmcnt(0)
    s_mov_b32 m0, s12
    s_nop 0
    buffer_load_dwordx4 v4, s[64:67], s11 offen lds
    s_add_u32 s12, s12, 1024
    s_add_u32 s11, s11, 110592
    s_waitcnt vmcnt(4)
    s_mov_b32 m0, s12
    s_nop 0
    buffer_load_dwordx4 v4, s[64:67], s11 offen lds
    s_add_u32 s12, s12, 1024
    s_add_u32 s11, s11, 110592
    s_waitcnt vmcnt(4)
    s_mov_b32 m0, s12
    s_nop 0
    buffer_load_dwordx4 v4, s[64:67], s11 offen lds
    s_add_u32 s12, s12, 1024
    s_add_u32 s11, s11, 110592
    s_waitcnt vmcnt(4)
    s_mov_b32 m0, s12
    s_nop 0
    buffer_load_dwordx4 v4, s[64:67], s11 offen lds
    s_add_u32 s12, s12, 1024
    s_add_u32 s11, s11, 110592
    s_waitcnt vmcnt(4)
    s_mov_b32 m0, s12
    s_nop 0
    buffer_load_dwordx4 v4, s[64:67], s13 offen lds
    s_add_u32 s12, s12, 1024
    s_add_u32 s11, s11, 110592
    s_waitcnt vmcnt(4)
    s_waitcnt vmcnt(0)
    s_barrier
    ds_read_b64_tr_b16 v[104:105], v9 offset:0
    ds_read_b64_tr_b16 v[106:107], v9 offset:128
    ds_read_b64_tr_b16 v[108:109], v9 offset:1024
    ds_read_b64_tr_b16 v[110:111], v9 offset:1152
    ds_read_b64_tr_b16 v[112:113], v9 offset:20480
    ds_read_b64_tr_b16 v[114:115], v9 offset:20608
    ds_read_b64_tr_b16 v[116:117], v9 offset:21504
    ds_read_b64_tr_b16 v[118:119], v9 offset:21632
    ds_read_b64_tr_b16 v[120:121], v7 offset:4096
    ds_read_b64_tr_b16 v[122:123], v7 offset:24576
H_SEL:
    s_waitcnt lgkmcnt(0)
    v_lshrrev_b32 v2, 1, v0
    v_and_b32 v3, 1, v0
    v_lshlrev_b32 v2, 7, v2
    v_lshl_add_u32 v2, v3, 4, v2
    s_mov_b32 s7, 524288
    s_lshl_b32 s8, s3, 2
    v_mov_b32 v3, s8
    v_mov_b32 v4, 0
    v_and_b32 v6, 31, v1
    v_lshlrev_b32 v6, 2, v6
    v_lshrrev_b32 v7, 5, v1
    v_lshlrev_b32 v7, 6, v7
    v_and_b32 v10, 7, v1
    v_lshlrev_b32 v10, 2, v10
    s_mov_b32 s61, 0x05040100
    v_lshrrev_b32 v32, 1, v0
    v_and_b32 v33, 1, v0
    v_lshl_add_u32 v32, v33, 10, v32
    v_sub_u32 v32, 2047, v32
    s_mov_b32 s60, 0xffff0000
    s_lshr_b32 s8, s42, 3
    s_mul_i32 s9, s42, 5
    s_add_u32 s8, s8, s9
    s_and_b32 s8, s8, 31
    s_lshl_b32 s8, s8, 1
    s_lshl_b64 exec, 1, s8
E3G_NS:
    s_mov_b32 s15, 65536
E3G_LOOP:
    s_sleep 1
    buffer_load_dwordx4 v[12:15], v2, s[44:47], s7 offen sc1
    s_waitcnt vmcnt(0)
    v_perm_b32 v8, v13, v12, s61
    v_perm_b32 v9, v15, v14, s61
    v_xor_b32 v8, s1, v8
    v_xor_b32 v9, s1, v9
    v_or_b32 v8, v8, v9
    v_cmp_ne_u32 vcc, 0, v8
    s_sub_u32 s15, s15, 1
    s_cbranch_scc1 E3G_DONE
    s_cbranch_vccz E3G_DONE
    s_branch E3G_LOOP
E3G_DONE:
    s_mov_b64 exec, -1
E3_NS:
    s_mov_b32 s15, 65536
    buffer_load_dwordx4 v[12:15], v2, s[44:47], s7 offen
    s_waitcnt vmcnt(0)
    s_branch E3_CHK
E3_LOOP:
    buffer_load_dwordx4 v[12:15], v2, s[44:47], s7 offen sc1
    s_waitcnt vmcnt(0)
E3_CHK:
    v_perm_b32 v8, v13, v12, s61
    v_perm_b32 v9, v15, v14, s61
    v_xor_b32 v8, s1, v8
    v_xor_b32 v9, s1, v9
    v_or_b32 v8, v8, v9
    v_cmp_ne_u32 vcc, 0, v8
    s_sub_u32 s15, s15, 1
    s_cbranch_scc1 E3_DONE
    s_cbranch_vccz E3_DONE
    s_mov_b64 exec, vcc
    s_branch E3_LOOP
E3_DONE:
    s_mov_b64 exec, -1
    v_and_or_b32 v12, v12, s60, v32
    v_subrev_u32 v32, 256, v32
    v_and_or_b32 v13, v13, s60, v32
    v_subrev_u32 v32, 256, v32
    v_and_or_b32 v14, v14, s60, v32
    v_subrev_u32 v32, 256, v32
    v_and_or_b32 v15, v15, s60, v32
    v_max3_u32 v9, v12, v13, v14
    v_max_u32 v9, v9, v15
    ds_write_b32 v35, v4 offset:0
    s_nop 0
    v_max_u32_dpp v9, v9, v9 row_ror:8 row_mask:0xf bank_mask:0xf
    s_nop 1
    v_max_u32_dpp v9, v9, v9 row_ror:4 row_mask:0xf bank_mask:0xf
    s_nop 1
    v_max_u32_dpp v9, v9, v9 row_ror:2 row_mask:0xf bank_mask:0xf
    s_nop 1
    v_max_u32_dpp v9, v9, v9 row_ror:1 row_mask:0xf bank_mask:0xf
    s_nop 1
    v_max_u32_dpp v9, v9, v9 row_bcast:15 row_mask:0xa bank_mask:0xf
    s_nop 1
    v_max_u32_dpp v9, v9, v9 row_bcast:31 row_mask:0xc bank_mask:0xf
    s_mov_b32 exec_lo, 0
    s_mov_b32 exec_hi, 0x80000000
    ds_write_b32 v3, v9 offset:8448
    s_mov_b64 exec, -1
    s_waitcnt lgkmcnt(0)
    s_barrier
    ds_read_b128 v[16:19], v4 offset:8448
    ds_read_b128 v[20:23], v4 offset:8464
    s_waitcnt lgkmcnt(0)
    v_min3_u32 v16, v16, v17, v18
    v_min3_u32 v20, v20, v21, v22
    v_min3_u32 v16, v16, v19, v23
    v_min_u32 v16, v16, v20
    v_cmp_ge_u32 s[68:69], v12, v16
    v_cmp_ge_u32 s[70:71], v13, v16
    v_cmp_ge_u32 s[72:73], v14, v16
    v_cmp_ge_u32 s[74:75], v15, v16
    s_bcnt1_i32_b64 s8, s[68:69]
    s_bcnt1_i32_b64 s9, s[70:71]
    s_bcnt1_i32_b64 s10, s[72:73]
    s_bcnt1_i32_b64 s11, s[74:75]
    s_add_u32 s9, s9, s8
    s_add_u32 s10, s10, s9
    s_add_u32 s11, s11, s10
    v_mov_b32 v9, s11
    s_mov_b64 exec, 1
    ds_add_rtn_u32 v8, v4, v9 offset:8512
    s_mov_b64 exec, -1
    v_mbcnt_lo_u32_b32 v16, s68, 0
    v_mbcnt_hi_u32_b32 v16, s69, v16
    v_mbcnt_lo_u32_b32 v17, s70, 0
    v_mbcnt_hi_u32_b32 v17, s71, v17
    v_add_u32 v17, s8, v17
    v_mbcnt_lo_u32_b32 v18, s72, 0
    v_mbcnt_hi_u32_b32 v18, s73, v18
    v_add_u32 v18, s9, v18
    v_mbcnt_lo_u32_b32 v19, s74, 0
    v_mbcnt_hi_u32_b32 v19, s75, v19
    v_add_u32 v19, s10, v19
    s_waitcnt lgkmcnt(0)
    v_readfirstlane_b32 s8, v8
    s_nop 1
    v_add_lshl_u32 v16, v16, s8, 2
    v_add_lshl_u32 v17, v17, s8, 2
    v_add_lshl_u32 v18, v18, s8, 2
    v_add_lshl_u32 v19, v19, s8, 2
    s_mov_b64 exec, s[68:69]
    ds_write_b32 v16, v12 offset:0
    s_mov_b64 exec, s[70:71]
    ds_write_b32 v17, v13 offset:0
    s_mov_b64 exec, s[72:73]
    ds_write_b32 v18, v14 offset:0
    s_mov_b64 exec, s[74:75]
    ds_write_b32 v19, v15 offset:0
    s_mov_b64 exec, -1
    s_waitcnt lgkmcnt(0)
    s_barrier
    ds_read_b32 v8, v4 offset:8512
    ds_read_b32 v9, v6 offset:0
    ds_read_b128 v[16:19], v7 offset:0
    ds_read_b128 v[20:23], v7 offset:16
    ds_read_b128 v[24:27], v7 offset:32
    ds_read_b128 v[28:31], v7 offset:48
    v_mov_b32 v11, 0
    s_waitcnt lgkmcnt(4)
    v_readfirstlane_b32 s8, v8
    s_nop 1
    s_cmp_gt_u32 s8, 32
    s_cbranch_scc1 S_BIG
    s_waitcnt lgkmcnt(3)
    v_cmp_gt_u32 vcc, v16, v9
    s_nop 1
    v_addc_co_u32 v11, vcc, 0, v11, vcc
    v_cmp_gt_u32 vcc, v17, v9
    s_nop 1
    v_addc_co_u32 v11, vcc, 0, v11, vcc
    v_cmp_gt_u32 vcc, v18, v9
    s_nop 1
    v_addc_co_u32 v11, vcc, 0, v11, vcc
    v_cmp_gt_u32 vcc, v19, v9
    s_nop 1
    v_addc_co_u32 v11, vcc, 0, v11, vcc
    s_waitcnt lgkmcnt(2)
    v_cmp_gt_u32 vcc, v20, v9
    s_nop 1
    v_addc_co_u32 v11, vcc, 0, v11, vcc
    v_cmp_gt_u32 vcc, v21, v9
    s_nop 1
    v_addc_co_u32 v11, vcc, 0, v11, vcc
    v_cmp_gt_u32 vcc, v22, v9
    s_nop 1
    v_addc_co_u32 v11, vcc, 0, v11, vcc
    v_cmp_gt_u32 vcc, v23, v9
    s_nop 1
    v_addc_co_u32 v11, vcc, 0, v11, vcc
    s_waitcnt lgkmcnt(1)
    v_cmp_gt_u32 vcc, v24, v9
    s_nop 1
    v_addc_co_u32 v11, vcc, 0, v11, vcc
    v_cmp_gt_u32 vcc, v25, v9
    s_nop 1
    v_addc_co_u32 v11, vcc, 0, v11, vcc
    v_cmp_gt_u32 vcc, v26, v9
    s_nop 1
    v_addc_co_u32 v11, vcc, 0, v11, vcc
    v_cmp_gt_u32 vcc, v27, v9
    s_nop 1
    v_addc_co_u32 v11, vcc, 0, v11, vcc
    s_waitcnt lgkmcnt(0)
    v_cmp_gt_u32 vcc, v28, v9
    s_nop 1
    v_addc_co_u32 v11, vcc, 0, v11, vcc
    v_cmp_gt_u32 vcc, v29, v9
    s_nop 1
    v_addc_co_u32 v11, vcc, 0, v11, vcc
    v_cmp_gt_u32 vcc, v30, v9
    s_nop 1
    v_addc_co_u32 v11, vcc, 0, v11, vcc
    v_cmp_gt_u32 vcc, v31, v9
    s_nop 1
    v_addc_co_u32 v11, vcc, 0, v11, vcc
    v_mov_b32 v8, v11
    s_nop 1
    v_permlane32_swap_b32 v8, v11
    v_add_lshl_u32 v11, v8, v11, 2
S_PERM:
    ds_permute_b32 v38, v11, v9
    s_waitcnt lgkmcnt(0)
S_DONE:
    ds_bpermute_b32 v37, v10, v38
    v_and_b32 v2, 15, v1
    v_lshrrev_b32 v3, 4, v1
    s_cmp_eq_u32 s99, 2
    s_cbranch_scc1 K5
    s_and_b32 s8, s3, 3
    s_lshl_b32 s8, s8, 8
    s_add_u32 s8, s8, 25161728
    s_lshr_b32 s7, s3, 2
    s_lshl_b32 s7, s7, 7
    s_add_u32 s8, s8, s7
    v_mov_b32 v90, 0
    v_mov_b32 v91, 0
    v_mov_b32 v92, 0
    v_mov_b32 v93, 0
    v_lshlrev_b32 v11, 4, v3
    v_lshlrev_b32 v9, 8, v3
    v_lshl_add_u32 v9, v2, 2, v9
    s_lshl_b32 s7, s3, 9
    s_add_u32 s7, s7, 9216
    v_add_u32 v10, s7, v9
    s_mov_b32 exec_lo, 0x00ff00ff
    s_mov_b32 exec_hi, 0x00ff00ff
    s_waitcnt lgkmcnt(0)
    v_and_b32 v4, 2047, v37
    v_lshlrev_b32 v4, 12, v4
    v_sub_u32 v4, v11, v4
    v_add_u32 v4, s8, v4
E4_NS:
    s_mov_b32 s15, 65536
    buffer_load_dwordx4 v[80:83], v4, s[44:47], 0 offen offset:0
    buffer_load_dwordx4 v[40:43], v4, s[44:47], 0 offen offset:1024
    buffer_load_dwordx4 v[84:87], v4, s[44:47], 0 offen offset:64
    buffer_load_dwordx4 v[44:47], v4, s[44:47], 0 offen offset:1088
    s_waitcnt vmcnt(0)
    s_branch E4_CHK
E4_LOOP:
    buffer_load_dwordx4 v[80:83], v4, s[44:47], 0 offen offset:0 sc1
    buffer_load_dwordx4 v[40:43], v4, s[44:47], 0 offen offset:1024 sc1
    buffer_load_dwordx4 v[84:87], v4, s[44:47], 0 offen offset:64 sc1
    buffer_load_dwordx4 v[44:47], v4, s[44:47], 0 offen offset:1088 sc1
    s_waitcnt vmcnt(0)
E4_CHK:
    v_xor_b32 v60, s1, v83
    v_xor_b32 v61, s1, v87
    v_xor_b32 v62, s1, v43
    v_xor_b32 v63, s1, v47
    v_or3_b32 v60, v60, v61, v62
    v_or_b32 v60, v60, v63
    v_cmp_ne_u32 vcc, 0, v60
    s_sub_u32 s15, s15, 1
    s_cbranch_scc1 E4_DONE
    s_cbranch_vccz E4_DONE
    s_mov_b64 exec, vcc
    s_branch E4_LOOP
E4_DONE:
    s_mov_b64 exec, -1
    v_mov_b32 v83, v40
    v_mov_b32 v87, v44
    v_mov_b32 v88, v41
    v_mov_b32 v94, v41
    v_mov_b32 v89, v45
    v_mov_b32 v95, v45
    v_add_u32 v11, 4096, v10
    v_mfma_f32_16x16x32_bf16 v[72:75], v[80:83], v[104:107], 0
    v_mfma_f32_16x16x32_bf16 v[76:79], v[80:83], v[112:115], 0
    v_mfma_f32_16x16x32_bf16 v[72:75], v[84:87], v[108:111], v[72:75]
    v_mfma_f32_16x16x32_bf16 v[76:79], v[84:87], v[116:119], v[76:79]
    v_mfma_f32_16x16x32_bf16 v[72:75], v[88:91], v[120:123], v[72:75]
    v_mfma_f32_16x16x32_bf16 v[76:79], v[92:95], v[120:123], v[76:79]
    s_mov_b64 exec, 0xffffffff
    s_nop 5
    ds_write2_b32 v10, v72, v73 offset0:0 offset1:16
    ds_write2_b32 v10, v74, v75 offset0:32 offset1:48
    ds_write2_b32 v11, v76, v77 offset0:0 offset1:16
    ds_write2_b32 v11, v78, v79 offset0:32 offset1:48
    s_mov_b64 exec, -1
    s_lshl_b32 s7, s43, 8
    s_add_u32 s7, s7, 557056
    s_waitcnt lgkmcnt(0)
    s_barrier
    s_cmp_lg_u32 s3, 0
    s_cbranch_scc1 KM_END
    ds_read2st64_b64 v[40:43], v36 offset0:18 offset1:19
    ds_read2st64_b64 v[44:47], v36 offset0:20 offset1:21
    ds_read2st64_b64 v[48:51], v36 offset0:22 offset1:23
    ds_read2st64_b64 v[52:55], v36 offset0:24 offset1:25
    ds_read2st64_b64 v[56:59], v36 offset0:26 offset1:27
    ds_read2st64_b64 v[60:63], v36 offset0:28 offset1:29
    ds_read2st64_b64 v[64:67], v36 offset0:30 offset1:31
    ds_read2st64_b64 v[68:71], v36 offset0:32 offset1:33
    s_waitcnt lgkmcnt(4)
    v_pk_add_f32 v[40:41], v[40:41], v[42:43]
    v_pk_add_f32 v[44:45], v[44:45], v[46:47]
    v_pk_add_f32 v[48:49], v[48:49], v[50:51]
    v_pk_add_f32 v[52:53], v[52:53], v[54:55]
    v_pk_add_f32 v[40:41], v[40:41], v[44:45]
    v_pk_add_f32 v[48:49], v[48:49], v[52:53]
    v_pk_add_f32 v[16:17], v[40:41], v[48:49]
    s_waitcnt lgkmcnt(0)
    v_pk_add_f32 v[56:57], v[56:57], v[58:59]
    v_pk_add_f32 v[60:61], v[60:61], v[62:63]
    v_pk_add_f32 v[64:65], v[64:65], v[66:67]
    v_pk_add_f32 v[68:69], v[68:69], v[70:71]
    v_pk_add_f32 v[56:57], v[56:57], v[60:61]
    v_pk_add_f32 v[64:65], v[64:65], v[68:69]
    v_pk_add_f32 v[24:25], v[56:57], v[64:65]
    v_cvt_pk_bf16_f32 v16, 0, v16
    v_cvt_pk_bf16_f32 v17, 0, v17
    v_mul_f32 v12, 0xbfb8aa3b, v16
    v_mul_f32 v13, 0xbfb8aa3b, v17
    v_exp_f32 v12, v12
    v_exp_f32 v13, v13
    v_cvt_pk_bf16_f32 v24, 0, v24
    v_cvt_pk_bf16_f32 v25, 0, v25
    v_add_f32 v12, 1.0, v12
    v_add_f32 v13, 1.0, v13
    v_rcp_f32 v12, v12
    v_rcp_f32 v13, v13
    v_mul_f32 v12, v12, v16
    v_mul_f32 v13, v13, v17
    v_cvt_pk_bf16_f32 v12, 0, v12
    v_cvt_pk_bf16_f32 v13, 0, v13
    v_mul_f32 v12, v12, v24
    v_mul_f32 v13, v13, v25
    v_cvt_pk_bf16_f32 v12, v12, v13
    v_min_u32 v12, -2, v12
    buffer_store_dword v12, v35, s[44:47], s7 offen sc1
    s_branch KM_END
K5:
    v_lshrrev_b32 v4, 3, v1
    v_lshlrev_b32 v6, 2, v4
    ds_bpermute_b32 v39, v6, v38
    v_lshrrev_b32 v8, 3, v2
    v_and_b32 v11, 7, v2
    v_lshrrev_b32 v9, 1, v3
    v_cmp_eq_u32 s[60:61], v9, v8
    v_lshl_add_u32 v9, v8, 1, v9
    v_lshlrev_b32 v9, 8, v9
    v_lshl_add_u32 v9, v11, 5, v9
    v_and_b32 v10, 1, v3
    v_lshl_add_u32 v7, v10, 4, v9
    v_lshlrev_b32 v10, 7, v10
    v_lshl_add_u32 v10, v8, 8, v10
    v_lshl_add_u32 v10, v11, 2, v10
    s_lshl_b32 s7, s3, 9
    s_add_u32 s7, s7, 9216
    v_add_u32 v10, s7, v10
    s_lshl_b32 s7, s3, 10
    s_add_u32 s8, s7, 557056
    s_add_u32 s9, s8, 8192
    s_add_u32 s10, s8, 16384
    s_add_u32 s11, s8, 24576
    s_cmp_ge_u32 s3, 3
    s_cselect_b32 s11, 0x4000000, s11
    s_mov_b32 s56, s36
    s_mov_b32 s57, s37
    s_mov_b32 s58, 0x280000
    s_mov_b32 s59, 0x20000
    s_waitcnt lgkmcnt(0)
    s_cmp_lg_u32 s3, 7
    s_cbranch_scc1 K5_W
    v_and_b32 v8, 7, v1
    v_add_u32 v11, s43, v8
    v_and_b32 v12, 2047, v39
    v_sub_u32 v12, 2047, v12
    s_movk_i32 s7, 1280
    v_lshlrev_b32 v13, 1, v11
    v_mad_u32_u24 v6, v12, s7, v13
    v_lshlrev_b32 v12, 12, v12
    s_lshl_b32 s12, s43, 1
    s_mov_b32 s64, 0x0c0c0c0c
    s_mov_b32 s66, 0x30303030
    v_and_b32 v13, 6, v1
    v_cmp_eq_u32 vcc, 6, v13
    v_lshlrev_b32 v13, 3, v13
    v_mov_b32 v14, 1024
    v_cndmask_b32 v14, 0, v14, vcc
    s_cmp_lt_u32 s43, 512
    s_cbranch_scc1 K5_LO
    s_lshl_b32 s12, s43, 3
    s_sub_u32 s12, s12, 3072
    s_mov_b32 s64, -1
    s_mov_b32 s66, 0
    v_mov_b32 v14, v13
K5_LO:
    s_mov_b32 s65, s64
    s_mov_b32 s67, s66
    s_add_u32 s13, s12, 16777216
    v_add_u32 v12, v12, v14
    v_ashrrev_i32 v14, 31, v39
    v_not_b32 v14, v14
    v_or_b32 v14, 0x80000000, v14
    v_xor_b32 v14, v14, v39
    v_and_b32 v14, 0xffff0000, v14
    v_mul_f32 v14, 0xbfb8aa3b, v14
    v_exp_f32 v14, v14
    s_nop 0
    v_add_f32 v14, 1.0, v14
    v_rcp_f32 v14, v14
    s_nop 0
    v_cvt_pk_bf16_f32 v123, 0, v14
    v_lshlrev_b32 v11, 2, v11
    s_mov_b32 s12, 269824
    buffer_load_dword v122, v11, s[44:47], s12 offen sc1
E5_NS:
    s_mov_b32 s15, 65536
    buffer_load_dwordx4 v[40:43], v12, s[44:47], s13 offen
    buffer_load_dwordx4 v[44:47], v12, s[44:47], s13 offen offset:2048
    s_waitcnt vmcnt(0)
    s_branch E5_CHK
E5_LOOP:
    buffer_load_dwordx4 v[40:43], v12, s[44:47], s13 offen sc1
    buffer_load_dwordx4 v[44:47], v12, s[44:47], s13 offen offset:2048 sc1
    s_waitcnt vmcnt(0)
E5_CHK:
    v_xor_b32 v14, s1, v43
    v_xor_b32 v15, s1, v47
    v_or_b32 v14, v14, v15
    v_cmp_ne_u32 vcc, 0, v14
    s_sub_u32 s15, s15, 1
    s_cbranch_scc1 E5_DONE
    s_cbranch_vccz E5_DONE
    s_mov_b64 exec, vcc
    s_branch E5_LOOP
E5_DONE:
    s_mov_b64 exec, -1
    v_cndmask_b32 v120, v40, v41, s[64:65]
    v_cndmask_b32 v121, v44, v45, s[64:65]
    v_cndmask_b32 v120, v120, v42, s[66:67]
    v_cndmask_b32 v121, v121, v46, s[66:67]
    v_and_b32 v8, 1, v1
    v_cmp_eq_u32 s[62:63], 0, v8
    v_and_b32 v122, 0xffff0000, v122
    s_branch K5_W3
K5_W:
    s_cmp_lg_u32 s3, 0
    s_cbranch_scc1 K5_W2
    v_readlane_b32 s12, v38, 7
    s_movk_i32 s13, 10240
    v_mul_u32_u24 v12, s13, v1
    s_lshl_b32 s13, s43, 4
    s_cmp_lt_u32 s43, 128
    s_cselect_b32 exec_lo, 15, 7
    s_mov_b32 exec_hi, 0
    s_add_u32 s13, s13, 589824
    v_mov_b32 v40, s12
    v_mov_b32 v41, s1
    buffer_store_dwordx2 v[40:41], v12, s[44:47], s13 offen sc1
    s_mov_b64 exec, -1
K5_W2:
    s_sleep 12
K5_W3:
E6_NS:
    s_mov_b32 s15, 65536
    buffer_load_dwordx4 v[16:19], v7, s[44:47], s8 offen
    buffer_load_dwordx4 v[20:23], v7, s[44:47], s9 offen
    buffer_load_dwordx4 v[24:27], v7, s[44:47], s10 offen
    buffer_load_dwordx4 v[28:31], v7, s[44:47], s11 offen
    s_waitcnt vmcnt(0)
    s_branch E6_CHK
E6_LOOP:
    buffer_load_dwordx4 v[16:19], v7, s[44:47], s8 offen sc1
    buffer_load_dwordx4 v[20:23], v7, s[44:47], s9 offen sc1
    buffer_load_dwordx4 v[24:27], v7, s[44:47], s10 offen sc1
    buffer_load_dwordx4 v[28:31], v7, s[44:47], s11 offen sc1
    s_waitcnt vmcnt(0)
E6_CHK:
    v_max3_u32 v56, v16, v17, v18
    v_max3_u32 v57, v19, v20, v21
    v_max3_u32 v58, v22, v23, v24
    v_max3_u32 v59, v25, v26, v27
    v_max3_u32 v60, v28, v29, v30
    v_max3_u32 v61, v56, v57, v58
    v_max3_u32 v62, v59, v60, v31
    v_max_u32 v56, v61, v62
    v_cmp_eq_u32 vcc, -1, v56
    s_sub_u32 s15, s15, 1
    s_cbranch_scc1 E6_DONE
    s_cbranch_vccz E6_DONE
    s_mov_b64 exec, vcc
    s_branch E6_LOOP
E6_DONE:
    s_mov_b64 exec, -1
    s_waitcnt lgkmcnt(0)
    v_mfma_f32_16x16x32_bf16 v[72:75], v[16:19], v[104:107], 0
    v_mfma_f32_16x16x32_bf16 v[76:79], v[20:23], v[108:111], 0
    v_mfma_f32_16x16x32_bf16 v[72:75], v[24:27], v[112:115], v[72:75]
    v_mfma_f32_16x16x32_bf16 v[76:79], v[28:31], v[116:119], v[76:79]
    v_lshlrev_b32 v14, 16, v120
    v_and_b32 v120, 0xffff0000, v120
    v_cndmask_b32 v120, v120, v14, s[62:63]
    v_lshlrev_b32 v14, 16, v121
    v_and_b32 v121, 0xffff0000, v121
    v_cndmask_b32 v121, v121, v14, s[62:63]
    s_nop 1
    v_pk_add_f32 v[72:73], v[72:73], v[76:77]
    v_pk_add_f32 v[74:75], v[74:75], v[78:79]
    s_mov_b64 exec, s[60:61]
    ds_write2_b32 v10, v72, v73 offset0:0 offset1:8
    ds_write2_b32 v10, v74, v75 offset0:16 offset1:24
    s_mov_b64 exec, -1
    s_waitcnt lgkmcnt(0)
    s_barrier
    s_cmp_lg_u32 s3, 7
    s_cbranch_scc1 KM_END
    ds_read2st64_b32 v[16:17], v35 offset0:36 offset1:37
    ds_read2st64_b32 v[18:19], v35 offset0:38 offset1:39
    ds_read2st64_b32 v[20:21], v35 offset0:40 offset1:41
    ds_read2st64_b32 v[22:23], v35 offset0:42 offset1:43
    ds_read2st64_b32 v[24:25], v35 offset0:44 offset1:45
    ds_read2st64_b32 v[26:27], v35 offset0:46 offset1:47
    ds_read2st64_b32 v[28:29], v35 offset0:48 offset1:49
    ds_read2st64_b32 v[30:31], v35 offset0:50 offset1:51
    s_waitcnt lgkmcnt(0)
    v_pk_add_f32 v[16:17], v[16:17], v[18:19]
    v_pk_add_f32 v[20:21], v[20:21], v[22:23]
    v_pk_add_f32 v[24:25], v[24:25], v[26:27]
    v_pk_add_f32 v[28:29], v[28:29], v[30:31]
    v_pk_add_f32 v[16:17], v[16:17], v[20:21]
    v_pk_add_f32 v[24:25], v[24:25], v[28:29]
    v_pk_add_f32 v[16:17], v[16:17], v[24:25]
    v_add_f32 v16, v16, v17
    v_cvt_pk_bf16_f32 v16, 0, v16
    v_mul_f32 v16, v16, v123
    v_cvt_pk_bf16_f32 v16, 0, v16
    v_add_f32 v16, v16, v120
    v_cvt_pk_bf16_f32 v16, 0, v16
    v_mul_f32 v16, v16, v122
    v_cvt_pk_bf16_f32 v16, 0, v16
    v_add_f32 v16, v16, v121
    v_cvt_pk_bf16_f32 v16, 0, v16
    buffer_store_short_d16_hi v16, v6, s[56:59], 0 offen sc1
KM_END:
KM_EXIT:
    s_endpgm
S_BIG:
    s_cmp_gt_u32 s8, 64
    s_cbranch_scc1 S_SLOW
    ds_read_b32 v9, v35 offset:0
    ds_read_b128 v[40:43], v4 offset:0
    ds_read_b128 v[44:47], v4 offset:16
    ds_read_b128 v[48:51], v4 offset:32
    ds_read_b128 v[52:55], v4 offset:48
    ds_read_b128 v[56:59], v4 offset:64
    ds_read_b128 v[60:63], v4 offset:80
    ds_read_b128 v[64:67], v4 offset:96
    ds_read_b128 v[68:71], v4 offset:112
    ds_read_b128 v[72:75], v4 offset:128
    ds_read_b128 v[76:79], v4 offset:144
    ds_read_b128 v[80:83], v4 offset:160
    ds_read_b128 v[84:87], v4 offset:176
    ds_read_b128 v[88:91], v4 offset:192
    ds_read_b128 v[92:95], v4 offset:208
    ds_read_b128 v[96:99], v4 offset:224
    ds_read_b128 v[100:103], v4 offset:240
    s_waitcnt lgkmcnt(0)
    v_cmp_gt_u32 vcc, v40, v9
    s_nop 1
    v_addc_co_u32 v11, vcc, 0, v11, vcc
    v_cmp_gt_u32 vcc, v41, v9
    s_nop 1
    v_addc_co_u32 v11, vcc, 0, v11, vcc
    v_cmp_gt_u32 vcc, v42, v9
    s_nop 1
    v_addc_co_u32 v11, vcc, 0, v11, vcc
    v_cmp_gt_u32 vcc, v43, v9
    s_nop 1
    v_addc_co_u32 v11, vcc, 0, v11, vcc
    v_cmp_gt_u32 vcc, v44, v9
    s_nop 1
    v_addc_co_u32 v11, vcc, 0, v11, vcc
    v_cmp_gt_u32 vcc, v45, v9
    s_nop 1
    v_addc_co_u32 v11, vcc, 0, v11, vcc
    v_cmp_gt_u32 vcc, v46, v9
    s_nop 1
    v_addc_co_u32 v11, vcc, 0, v11, vcc
    v_cmp_gt_u32 vcc, v47, v9
    s_nop 1
    v_addc_co_u32 v11, vcc, 0, v11, vcc
    v_cmp_gt_u32 vcc, v48, v9
    s_nop 1
    v_addc_co_u32 v11, vcc, 0, v11, vcc
    v_cmp_gt_u32 vcc, v49, v9
    s_nop 1
    v_addc_co_u32 v11, vcc, 0, v11, vcc
    v_cmp_gt_u32 vcc, v50, v9
    s_nop 1
    v_addc_co_u32 v11, vcc, 0, v11, vcc
    v_cmp_gt_u32 vcc, v51, v9
    s_nop 1
    v_addc_co_u32 v11, vcc, 0, v11, vcc
    v_cmp_gt_u32 vcc, v52, v9
    s_nop 1
    v_addc_co_u32 v11, vcc, 0, v11, vcc
    v_cmp_gt_u32 vcc, v53, v9
    s_nop 1
    v_addc_co_u32 v11, vcc, 0, v11, vcc
    v_cmp_gt_u32 vcc, v54, v9
    s_nop 1
    v_addc_co_u32 v11, vcc, 0, v11, vcc
    v_cmp_gt_u32 vcc, v55, v9
    s_nop 1
    v_addc_co_u32 v11, vcc, 0, v11, vcc
    v_cmp_gt_u32 vcc, v56, v9
    s_nop 1
    v_addc_co_u32 v11, vcc, 0, v11, vcc
    v_cmp_gt_u32 vcc, v57, v9
    s_nop 1
    v_addc_co_u32 v11, vcc, 0, v11, vcc
    v_cmp_gt_u32 vcc, v58, v9
    s_nop 1
    v_addc_co_u32 v11, vcc, 0, v11, vcc
    v_cmp_gt_u32 vcc, v59, v9
    s_nop 1
    v_addc_co_u32 v11, vcc, 0, v11, vcc
    v_cmp_gt_u32 vcc, v60, v9
    s_nop 1
    v_addc_co_u32 v11, vcc, 0, v11, vcc
    v_cmp_gt_u32 vcc, v61, v9
    s_nop 1
    v_addc_co_u32 v11, vcc, 0, v11, vcc
    v_cmp_gt_u32 vcc, v62, v9
    s_nop 1
    v_addc_co_u32 v11, vcc, 0, v11, vcc
    v_cmp_gt_u32 vcc, v63, v9
    s_nop 1
    v_addc_co_u32 v11, vcc, 0, v11, vcc
    v_cmp_gt_u32 vcc, v64, v9
    s_nop 1
    v_addc_co_u32 v11, vcc, 0, v11, vcc
    v_cmp_gt_u32 vcc, v65, v9
    s_nop 1
    v_addc_co_u32 v11, vcc, 0, v11, vcc
    v_cmp_gt_u32 vcc, v66, v9
    s_nop 1
    v_addc_co_u32 v11, vcc, 0, v11, vcc
    v_cmp_gt_u32 vcc, v67, v9
    s_nop 1
    v_addc_co_u32 v11, vcc, 0, v11, vcc
    v_cmp_gt_u32 vcc, v68, v9
    s_nop 1
    v_addc_co_u32 v11, vcc, 0, v11, vcc
    v_cmp_gt_u32 vcc, v69, v9
    s_nop 1
    v_addc_co_u32 v11, vcc, 0, v11, vcc
    v_cmp_gt_u32 vcc, v70, v9
    s_nop 1
    v_addc_co_u32 v11, vcc, 0, v11, vcc
    v_cmp_gt_u32 vcc, v71, v9
    s_nop 1
    v_addc_co_u32 v11, vcc, 0, v11, vcc
    v_cmp_gt_u32 vcc, v72, v9
    s_nop 1
    v_addc_co_u32 v11, vcc, 0, v11, vcc
    v_cmp_gt_u32 vcc, v73, v9
    s_nop 1
    v_addc_co_u32 v11, vcc, 0, v11, vcc
    v_cmp_gt_u32 vcc, v74, v9
    s_nop 1
    v_addc_co_u32 v11, vcc, 0, v11, vcc
    v_cmp_gt_u32 vcc, v75, v9
    s_nop 1
    v_addc_co_u32 v11, vcc, 0, v11, vcc
    v_cmp_gt_u32 vcc, v76, v9
    s_nop 1
    v_addc_co_u32 v11, vcc, 0, v11, vcc
    v_cmp_gt_u32 vcc, v77, v9
    s_nop 1
    v_addc_co_u32 v11, vcc, 0, v11, vcc
    v_cmp_gt_u32 vcc, v78, v9
    s_nop 1
    v_addc_co_u32 v11, vcc, 0, v11, vcc
    v_cmp_gt_u32 vcc, v79, v9
    s_nop 1
    v_addc_co_u32 v11, vcc, 0, v11, vcc
    v_cmp_gt_u32 vcc, v80, v9
    s_nop 1
    v_addc_co_u32 v11, vcc, 0, v11, vcc
    v_cmp_gt_u32 vcc, v81, v9
    s_nop 1
    v_addc_co_u32 v11, vcc, 0, v11, vcc
    v_cmp_gt_u32 vcc, v82, v9
    s_nop 1
    v_addc_co_u32 v11, vcc, 0, v11, vcc
    v_cmp_gt_u32 vcc, v83, v9
    s_nop 1
    v_addc_co_u32 v11, vcc, 0, v11, vcc
    v_cmp_gt_u32 vcc, v84, v9
    s_nop 1
    v_addc_co_u32 v11, vcc, 0, v11, vcc
    v_cmp_gt_u32 vcc, v85, v9
    s_nop 1
    v_addc_co_u32 v11, vcc, 0, v11, vcc
    v_cmp_gt_u32 vcc, v86, v9
    s_nop 1
    v_addc_co_u32 v11, vcc, 0, v11, vcc
    v_cmp_gt_u32 vcc, v87, v9
    s_nop 1
    v_addc_co_u32 v11, vcc, 0, v11, vcc
    v_cmp_gt_u32 vcc, v88, v9
    s_nop 1
    v_addc_co_u32 v11, vcc, 0, v11, vcc
    v_cmp_gt_u32 vcc, v89, v9
    s_nop 1
    v_addc_co_u32 v11, vcc, 0, v11, vcc
    v_cmp_gt_u32 vcc, v90, v9
    s_nop 1
    v_addc_co_u32 v11, vcc, 0, v11, vcc
    v_cmp_gt_u32 vcc, v91, v9
    s_nop 1
    v_addc_co_u32 v11, vcc, 0, v11, vcc
    v_cmp_gt_u32 vcc, v92, v9
    s_nop 1
    v_addc_co_u32 v11, vcc, 0, v11, vcc
    v_cmp_gt_u32 vcc, v93, v9
    s_nop 1
    v_addc_co_u32 v11, vcc, 0, v11, vcc
    v_cmp_gt_u32 vcc, v94, v9
    s_nop 1
    v_addc_co_u32 v11, vcc, 0, v11, vcc
    v_cmp_gt_u32 vcc, v95, v9
    s_nop 1
    v_addc_co_u32 v11, vcc, 0, v11, vcc
    v_cmp_gt_u32 vcc, v96, v9
    s_nop 1
    v_addc_co_u32 v11, vcc, 0, v11, vcc
    v_cmp_gt_u32 vcc, v97, v9
    s_nop 1
    v_addc_co_u32 v11, vcc, 0, v11, vcc
    v_cmp_gt_u32 vcc, v98, v9
    s_nop 1
    v_addc_co_u32 v11, vcc, 0, v11, vcc
    v_cmp_gt_u32 vcc, v99, v9
    s_nop 1
    v_addc_co_u32 v11, vcc, 0, v11, vcc
    v_cmp_gt_u32 vcc, v100, v9
    s_nop 1
    v_addc_co_u32 v11, vcc, 0, v11, vcc
    v_cmp_gt_u32 vcc, v101, v9
    s_nop 1
    v_addc_co_u32 v11, vcc, 0, v11, vcc
    v_cmp_gt_u32 vcc, v102, v9
    s_nop 1
    v_addc_co_u32 v11, vcc, 0, v11, vcc
    v_cmp_gt_u32 vcc, v103, v9
    s_nop 1
    v_addc_co_u32 v11, vcc, 0, v11, vcc
    v_min_u32 v11, 63, v11
    v_lshlrev_b32 v11, 2, v11
    s_branch S_PERM
S_SLOW:
    s_waitcnt lgkmcnt(0)
    s_barrier
    s_mov_b32 s9, 0
    v_max3_u32 v9, v12, v13, v14
    v_max_u32 v9, v9, v15
    s_nop 1
    v_max_u32_dpp v9, v9, v9 row_ror:8 row_mask:0xf bank_mask:0xf
    s_nop 1
    v_max_u32_dpp v9, v9, v9 row_ror:4 row_mask:0xf bank_mask:0xf
    s_nop 1
    v_max_u32_dpp v9, v9, v9 row_ror:2 row_mask:0xf bank_mask:0xf
    s_nop 1
    v_max_u32_dpp v9, v9, v9 row_ror:1 row_mask:0xf bank_mask:0xf
    s_nop 1
    v_max_u32_dpp v9, v9, v9 row_bcast:15 row_mask:0xa bank_mask:0xf
    s_nop 1
    v_max_u32_dpp v9, v9, v9 row_bcast:31 row_mask:0xc bank_mask:0xf
    s_nop 0
    v_readlane_b32 s10, v9, 63
    s_nop 1
    v_subrev_u32 v12, s10, v12
    v_subrev_u32 v13, s10, v13
    v_subrev_u32 v14, s10, v14
    v_subrev_u32 v15, s10, v15
    s_add_u32 s9, s9, s10
    v_writelane_b32 v8, s9, 0
    v_max3_u32 v9, v12, v13, v14
    v_max_u32 v9, v9, v15
    s_nop 1
    v_max_u32_dpp v9, v9, v9 row_ror:8 row_mask:0xf bank_mask:0xf
    s_nop 1
    v_max_u32_dpp v9, v9, v9 row_ror:4 row_mask:0xf bank_mask:0xf
    s_nop 1
    v_max_u32_dpp v9, v9, v9 row_ror:2 row_mask:0xf bank_mask:0xf
    s_nop 1
    v_max_u32_dpp v9, v9, v9 row_ror:1 row_mask:0xf bank_mask:0xf
    s_nop 1
    v_max_u32_dpp v9, v9, v9 row_bcast:15 row_mask:0xa bank_mask:0xf
    s_nop 1
    v_max_u32_dpp v9, v9, v9 row_bcast:31 row_mask:0xc bank_mask:0xf
    s_nop 0
    v_readlane_b32 s10, v9, 63
    s_nop 1
    v_subrev_u32 v12, s10, v12
    v_subrev_u32 v13, s10, v13
    v_subrev_u32 v14, s10, v14
    v_subrev_u32 v15, s10, v15
    s_add_u32 s9, s9, s10
    v_writelane_b32 v8, s9, 1
    v_max3_u32 v9, v12, v13, v14
    v_max_u32 v9, v9, v15
    s_nop 1
    v_max_u32_dpp v9, v9, v9 row_ror:8 row_mask:0xf bank_mask:0xf
    s_nop 1
    v_max_u32_dpp v9, v9, v9 row_ror:4 row_mask:0xf bank_mask:0xf
    s_nop 1
    v_max_u32_dpp v9, v9, v9 row_ror:2 row_mask:0xf bank_mask:0xf
    s_nop 1
    v_max_u32_dpp v9, v9, v9 row_ror:1 row_mask:0xf bank_mask:0xf
    s_nop 1
    v_max_u32_dpp v9, v9, v9 row_bcast:15 row_mask:0xa bank_mask:0xf
    s_nop 1
    v_max_u32_dpp v9, v9, v9 row_bcast:31 row_mask:0xc bank_mask:0xf
    s_nop 0
    v_readlane_b32 s10, v9, 63
    s_nop 1
    v_subrev_u32 v12, s10, v12
    v_subrev_u32 v13, s10, v13
    v_subrev_u32 v14, s10, v14
    v_subrev_u32 v15, s10, v15
    s_add_u32 s9, s9, s10
    v_writelane_b32 v8, s9, 2
    v_max3_u32 v9, v12, v13, v14
    v_max_u32 v9, v9, v15
    s_nop 1
    v_max_u32_dpp v9, v9, v9 row_ror:8 row_mask:0xf bank_mask:0xf
    s_nop 1
    v_max_u32_dpp v9, v9, v9 row_ror:4 row_mask:0xf bank_mask:0xf
    s_nop 1
    v_max_u32_dpp v9, v9, v9 row_ror:2 row_mask:0xf bank_mask:0xf
    s_nop 1
    v_max_u32_dpp v9, v9, v9 row_ror:1 row_mask:0xf bank_mask:0xf
    s_nop 1
    v_max_u32_dpp v9, v9, v9 row_bcast:15 row_mask:0xa bank_mask:0xf
    s_nop 1
    v_max_u32_dpp v9, v9, v9 row_bcast:31 row_mask:0xc bank_mask:0xf
    s_nop 0
    v_readlane_b32 s10, v9, 63
    s_nop 1
    v_subrev_u32 v12, s10, v12
    v_subrev_u32 v13, s10, v13
    v_subrev_u32 v14, s10, v14
    v_subrev_u32 v15, s10, v15
    s_add_u32 s9, s9, s10
    v_writelane_b32 v8, s9, 3
    v_max3_u32 v9, v12, v13, v14
    v_max_u32 v9, v9, v15
    s_nop 1
    v_max_u32_dpp v9, v9, v9 row_ror:8 row_mask:0xf bank_mask:0xf
    s_nop 1
    v_max_u32_dpp v9, v9, v9 row_ror:4 row_mask:0xf bank_mask:0xf
    s_nop 1
    v_max_u32_dpp v9, v9, v9 row_ror:2 row_mask:0xf bank_mask:0xf
    s_nop 1
    v_max_u32_dpp v9, v9, v9 row_ror:1 row_mask:0xf bank_mask:0xf
    s_nop 1
    v_max_u32_dpp v9, v9, v9 row_bcast:15 row_mask:0xa bank_mask:0xf
    s_nop 1
    v_max_u32_dpp v9, v9, v9 row_bcast:31 row_mask:0xc bank_mask:0xf
    s_nop 0
    v_readlane_b32 s10, v9, 63
    s_nop 1
    v_subrev_u32 v12, s10, v12
    v_subrev_u32 v13, s10, v13
    v_subrev_u32 v14, s10, v14
    v_subrev_u32 v15, s10, v15
    s_add_u32 s9, s9, s10
    v_writelane_b32 v8, s9, 4
    v_max3_u32 v9, v12, v13, v14
    v_max_u32 v9, v9, v15
    s_nop 1
    v_max_u32_dpp v9, v9, v9 row_ror:8 row_mask:0xf bank_mask:0xf
    s_nop 1
    v_max_u32_dpp v9, v9, v9 row_ror:4 row_mask:0xf bank_mask:0xf
    s_nop 1
    v_max_u32_dpp v9, v9, v9 row_ror:2 row_mask:0xf bank_mask:0xf
    s_nop 1
    v_max_u32_dpp v9, v9, v9 row_ror:1 row_mask:0xf bank_mask:0xf
    s_nop 1
    v_max_u32_dpp v9, v9, v9 row_bcast:15 row_mask:0xa bank_mask:0xf
    s_nop 1
    v_max_u32_dpp v9, v9, v9 row_bcast:31 row_mask:0xc bank_mask:0xf
    s_nop 0
    v_readlane_b32 s10, v9, 63
    s_nop 1
    v_subrev_u32 v12, s10, v12
    v_subrev_u32 v13, s10, v13
    v_subrev_u32 v14, s10, v14
    v_subrev_u32 v15, s10, v15
    s_add_u32 s9, s9, s10
    v_writelane_b32 v8, s9, 5
    v_max3_u32 v9, v12, v13, v14
    v_max_u32 v9, v9, v15
    s_nop 1
    v_max_u32_dpp v9, v9, v9 row_ror:8 row_mask:0xf bank_mask:0xf
    s_nop 1
    v_max_u32_dpp v9, v9, v9 row_ror:4 row_mask:0xf bank_mask:0xf
    s_nop 1
    v_max_u32_dpp v9, v9, v9 row_ror:2 row_mask:0xf bank_mask:0xf
    s_nop 1
    v_max_u32_dpp v9, v9, v9 row_ror:1 row_mask:0xf bank_mask:0xf
    s_nop 1
    v_max_u32_dpp v9, v9, v9 row_bcast:15 row_mask:0xa bank_mask:0xf
    s_nop 1
    v_max_u32_dpp v9, v9, v9 row_bcast:31 row_mask:0xc bank_mask:0xf
    s_nop 0
    v_readlane_b32 s10, v9, 63
    s_nop 1
    v_subrev_u32 v12, s10, v12
    v_subrev_u32 v13, s10, v13
    v_subrev_u32 v14, s10, v14
    v_subrev_u32 v15, s10, v15
    s_add_u32 s9, s9, s10
    v_writelane_b32 v8, s9, 6
    v_max3_u32 v9, v12, v13, v14
    v_max_u32 v9, v9, v15
    s_nop 1
    v_max_u32_dpp v9, v9, v9 row_ror:8 row_mask:0xf bank_mask:0xf
    s_nop 1
    v_max_u32_dpp v9, v9, v9 row_ror:4 row_mask:0xf bank_mask:0xf
    s_nop 1
    v_max_u32_dpp v9, v9, v9 row_ror:2 row_mask:0xf bank_mask:0xf
    s_nop 1
    v_max_u32_dpp v9, v9, v9 row_ror:1 row_mask:0xf bank_mask:0xf
    s_nop 1
    v_max_u32_dpp v9, v9, v9 row_bcast:15 row_mask:0xa bank_mask:0xf
    s_nop 1
    v_max_u32_dpp v9, v9, v9 row_bcast:31 row_mask:0xc bank_mask:0xf
    s_nop 0
    v_readlane_b32 s10, v9, 63
    s_nop 1
    s_add_u32 s9, s9, s10
    v_writelane_b32 v8, s9, 7
    s_lshl_b32 s7, s3, 5
    v_add_u32 v9, s7, v35
    s_mov_b64 exec, 0xff
    ds_write_b32 v9, v8 offset:0
    s_mov_b64 exec, -1
    s_waitcnt lgkmcnt(0)
    s_barrier
    ds_read_b32 v12, v35 offset:0
    s_mov_b32 s9, 0
    s_waitcnt lgkmcnt(0)
    v_mov_b32 v9, v12
    s_nop 1
    v_max_u32_dpp v9, v9, v9 row_ror:8 row_mask:0xf bank_mask:0xf
    s_nop 1
    v_max_u32_dpp v9, v9, v9 row_ror:4 row_mask:0xf bank_mask:0xf
    s_nop 1
    v_max_u32_dpp v9, v9, v9 row_ror:2 row_mask:0xf bank_mask:0xf
    s_nop 1
    v_max_u32_dpp v9, v9, v9 row_ror:1 row_mask:0xf bank_mask:0xf
    s_nop 1
    v_max_u32_dpp v9, v9, v9 row_bcast:15 row_mask:0xa bank_mask:0xf
    s_nop 1
    v_max_u32_dpp v9, v9, v9 row_bcast:31 row_mask:0xc bank_mask:0xf
    s_nop 0
    v_readlane_b32 s10, v9, 63
    s_nop 1
    s_add_u32 s9, s9, s10
    v_subrev_u32 v12, s10, v12
    v_writelane_b32 v38, s9, 0
    v_mov_b32 v9, v12
    s_nop 1
    v_max_u32_dpp v9, v9, v9 row_ror:8 row_mask:0xf bank_mask:0xf
    s_nop 1
    v_max_u32_dpp v9, v9, v9 row_ror:4 row_mask:0xf bank_mask:0xf
    s_nop 1
    v_max_u32_dpp v9, v9, v9 row_ror:2 row_mask:0xf bank_mask:0xf
    s_nop 1
    v_max_u32_dpp v9, v9, v9 row_ror:1 row_mask:0xf bank_mask:0xf
    s_nop 1
    v_max_u32_dpp v9, v9, v9 row_bcast:15 row_mask:0xa bank_mask:0xf
    s_nop 1
    v_max_u32_dpp v9, v9, v9 row_bcast:31 row_mask:0xc bank_mask:0xf
    s_nop 0
    v_readlane_b32 s10, v9, 63
    s_nop 1
    s_add_u32 s9, s9, s10
    v_subrev_u32 v12, s10, v12
    v_writelane_b32 v38, s9, 1
    v_mov_b32 v9, v12
    s_nop 1
    v_max_u32_dpp v9, v9, v9 row_ror:8 row_mask:0xf bank_mask:0xf
    s_nop 1
    v_max_u32_dpp v9, v9, v9 row_ror:4 row_mask:0xf bank_mask:0xf
    s_nop 1
    v_max_u32_dpp v9, v9, v9 row_ror:2 row_mask:0xf bank_mask:0xf
    s_nop 1
    v_max_u32_dpp v9, v9, v9 row_ror:1 row_mask:0xf bank_mask:0xf
    s_nop 1
    v_max_u32_dpp v9, v9, v9 row_bcast:15 row_mask:0xa bank_mask:0xf
    s_nop 1
    v_max_u32_dpp v9, v9, v9 row_bcast:31 row_mask:0xc bank_mask:0xf
    s_nop 0
    v_readlane_b32 s10, v9, 63
    s_nop 1
    s_add_u32 s9, s9, s10
    v_subrev_u32 v12, s10, v12
    v_writelane_b32 v38, s9, 2
    v_mov_b32 v9, v12
    s_nop 1
    v_max_u32_dpp v9, v9, v9 row_ror:8 row_mask:0xf bank_mask:0xf
    s_nop 1
    v_max_u32_dpp v9, v9, v9 row_ror:4 row_mask:0xf bank_mask:0xf
    s_nop 1
    v_max_u32_dpp v9, v9, v9 row_ror:2 row_mask:0xf bank_mask:0xf
    s_nop 1
    v_max_u32_dpp v9, v9, v9 row_ror:1 row_mask:0xf bank_mask:0xf
    s_nop 1
    v_max_u32_dpp v9, v9, v9 row_bcast:15 row_mask:0xa bank_mask:0xf
    s_nop 1
    v_max_u32_dpp v9, v9, v9 row_bcast:31 row_mask:0xc bank_mask:0xf
    s_nop 0
    v_readlane_b32 s10, v9, 63
    s_nop 1
    s_add_u32 s9, s9, s10
    v_subrev_u32 v12, s10, v12
    v_writelane_b32 v38, s9, 3
    v_mov_b32 v9, v12
    s_nop 1
    v_max_u32_dpp v9, v9, v9 row_ror:8 row_mask:0xf bank_mask:0xf
    s_nop 1
    v_max_u32_dpp v9, v9, v9 row_ror:4 row_mask:0xf bank_mask:0xf
    s_nop 1
    v_max_u32_dpp v9, v9, v9 row_ror:2 row_mask:0xf bank_mask:0xf
    s_nop 1
    v_max_u32_dpp v9, v9, v9 row_ror:1 row_mask:0xf bank_mask:0xf
    s_nop 1
    v_max_u32_dpp v9, v9, v9 row_bcast:15 row_mask:0xa bank_mask:0xf
    s_nop 1
    v_max_u32_dpp v9, v9, v9 row_bcast:31 row_mask:0xc bank_mask:0xf
    s_nop 0
    v_readlane_b32 s10, v9, 63
    s_nop 1
    s_add_u32 s9, s9, s10
    v_subrev_u32 v12, s10, v12
    v_writelane_b32 v38, s9, 4
    v_mov_b32 v9, v12
    s_nop 1
    v_max_u32_dpp v9, v9, v9 row_ror:8 row_mask:0xf bank_mask:0xf
    s_nop 1
    v_max_u32_dpp v9, v9, v9 row_ror:4 row_mask:0xf bank_mask:0xf
    s_nop 1
    v_max_u32_dpp v9, v9, v9 row_ror:2 row_mask:0xf bank_mask:0xf
    s_nop 1
    v_max_u32_dpp v9, v9, v9 row_ror:1 row_mask:0xf bank_mask:0xf
    s_nop 1
    v_max_u32_dpp v9, v9, v9 row_bcast:15 row_mask:0xa bank_mask:0xf
    s_nop 1
    v_max_u32_dpp v9, v9, v9 row_bcast:31 row_mask:0xc bank_mask:0xf
    s_nop 0
    v_readlane_b32 s10, v9, 63
    s_nop 1
    s_add_u32 s9, s9, s10
    v_subrev_u32 v12, s10, v12
    v_writelane_b32 v38, s9, 5
    v_mov_b32 v9, v12
    s_nop 1
    v_max_u32_dpp v9, v9, v9 row_ror:8 row_mask:0xf bank_mask:0xf
    s_nop 1
    v_max_u32_dpp v9, v9, v9 row_ror:4 row_mask:0xf bank_mask:0xf
    s_nop 1
    v_max_u32_dpp v9, v9, v9 row_ror:2 row_mask:0xf bank_mask:0xf
    s_nop 1
    v_max_u32_dpp v9, v9, v9 row_ror:1 row_mask:0xf bank_mask:0xf
    s_nop 1
    v_max_u32_dpp v9, v9, v9 row_bcast:15 row_mask:0xa bank_mask:0xf
    s_nop 1
    v_max_u32_dpp v9, v9, v9 row_bcast:31 row_mask:0xc bank_mask:0xf
    s_nop 0
    v_readlane_b32 s10, v9, 63
    s_nop 1
    s_add_u32 s9, s9, s10
    v_subrev_u32 v12, s10, v12
    v_writelane_b32 v38, s9, 6
    v_mov_b32 v9, v12
    s_nop 1
    v_max_u32_dpp v9, v9, v9 row_ror:8 row_mask:0xf bank_mask:0xf
    s_nop 1
    v_max_u32_dpp v9, v9, v9 row_ror:4 row_mask:0xf bank_mask:0xf
    s_nop 1
    v_max_u32_dpp v9, v9, v9 row_ror:2 row_mask:0xf bank_mask:0xf
    s_nop 1
    v_max_u32_dpp v9, v9, v9 row_ror:1 row_mask:0xf bank_mask:0xf
    s_nop 1
    v_max_u32_dpp v9, v9, v9 row_bcast:15 row_mask:0xa bank_mask:0xf
    s_nop 1
    v_max_u32_dpp v9, v9, v9 row_bcast:31 row_mask:0xc bank_mask:0xf
    s_nop 0
    v_readlane_b32 s10, v9, 63
    s_nop 1
    s_add_u32 s9, s9, s10
    v_writelane_b32 v38, s9, 7
    s_branch S_DONE
.p2align 8
.type tbl,@object
tbl:
.long 0x3e353e35, 0x3e353e35, 0x3e353e35, 0x3e353e35, 0x3e353e35, 0x3e353e35, 0x3e353e35, 0x3e353e35
.long 0x3e353e35, 0x3e353e35, 0x3e353e35, 0x3e353e35, 0x3e353e35, 0x3e353e35, 0x3e353e35, 0x3e353e35
.long 0x3e003e35, 0xbe000000, 0xbe00be35, 0x3e000000, 0x3e003e35, 0xbe000000, 0xbe00be35, 0x3e000000
.long 0x3e003e35, 0xbe000000, 0xbe00be35, 0x3e000000, 0x3e003e35, 0xbe000000, 0xbe00be35, 0x3e000000
.long 0x00003e35, 0x0000be35, 0x00003e35, 0x0000be35, 0x00003e35, 0x0000be35, 0x00003e35, 0x0000be35
.long 0x00003e35, 0x0000be35, 0x00003e35, 0x0000be35, 0x00003e35, 0x0000be35, 0x00003e35, 0x0000be35
.long 0xbe003e35, 0x3e000000, 0x3e00be35, 0xbe000000, 0xbe003e35, 0x3e000000, 0x3e00be35, 0xbe000000
.long 0xbe003e35, 0x3e000000, 0x3e00be35, 0xbe000000, 0xbe003e35, 0x3e000000, 0x3e00be35, 0xbe000000
.long 0x3e353e35, 0x3e353e35, 0x3e353e35, 0x3e353e35, 0xbe353e35, 0xbe353e35, 0xbe353e35, 0xbe353e35
.long 0xbe35be35, 0xbe35be35, 0xbe35be35, 0xbe35be35, 0x3e35be35, 0x3e35be35, 0x3e35be35, 0x3e35be35
.long 0x3e003e35, 0xbe000000, 0xbe00be35, 0x3e000000, 0xbe000000, 0xbe00be35, 0x3e000000, 0x3e003e35
.long 0xbe00be35, 0x3e000000, 0x3e003e35, 0xbe000000, 0x3e000000, 0x3e003e35, 0xbe000000, 0xbe00be35
.long 0x00003e35, 0x0000be35, 0x00003e35, 0x0000be35, 0xbe350000, 0x3e350000, 0xbe350000, 0x3e350000
.long 0x0000be35, 0x00003e35, 0x0000be35, 0x00003e35, 0x3e350000, 0xbe350000, 0x3e350000, 0xbe350000
.long 0xbe003e35, 0x3e000000, 0x3e00be35, 0xbe000000, 0xbe000000, 0xbe003e35, 0x3e000000, 0x3e00be35
.long 0x3e00be35, 0xbe000000, 0xbe003e35, 0x3e000000, 0x3e000000, 0x3e00be35, 0xbe000000, 0xbe003e35
.long 0x3e353e35, 0x3e353e35, 0x3e353e35, 0x3e353e35, 0xbe35be35, 0xbe35be35, 0xbe35be35, 0xbe35be35
.long 0x3e353e35, 0x3e353e35, 0x3e353e35, 0x3e353e35, 0xbe35be35, 0xbe35be35, 0xbe35be35, 0xbe35be35
.long 0x3e003e35, 0xbe000000, 0xbe00be35, 0x3e000000, 0xbe00be35, 0x3e000000, 0x3e003e35, 0xbe000000
.long 0x3e003e35, 0xbe000000, 0xbe00be35, 0x3e000000, 0xbe00be35, 0x3e000000, 0x3e003e35, 0xbe000000
.long 0x00003e35, 0x0000be35, 0x00003e35, 0x0000be35, 0x0000be35, 0x00003e35, 0x0000be35, 0x00003e35
.long 0x00003e35, 0x0000be35, 0x00003e35, 0x0000be35, 0x0000be35, 0x00003e35, 0x0000be35, 0x00003e35
.long 0xbe003e35, 0x3e000000, 0x3e00be35, 0xbe000000, 0x3e00be35, 0xbe000000, 0xbe003e35, 0x3e000000
.long 0xbe003e35, 0x3e000000, 0x3e00be35, 0xbe000000, 0x3e00be35, 0xbe000000, 0xbe003e35, 0x3e000000
.long 0x3e353e35, 0x3e353e35, 0x3e353e35, 0x3e353e35, 0x3e35be35, 0x3e35be35, 0x3e35be35, 0x3e35be35
.long 0xbe35be35, 0xbe35be35, 0xbe35be35, 0xbe35be35, 0xbe353e35, 0xbe353e35, 0xbe353e35, 0xbe353e35
.long 0x3e003e35, 0xbe000000, 0xbe00be35, 0x3e000000, 0x3e000000, 0x3e003e35, 0xbe000000, 0xbe00be35
.long 0xbe00be35, 0x3e000000, 0x3e003e35, 0xbe000000, 0xbe000000, 0xbe00be35, 0x3e000000, 0x3e003e35
.long 0x00003e35, 0x0000be35, 0x00003e35, 0x0000be35, 0x3e350000, 0xbe350000, 0x3e350000, 0xbe350000
.long 0x0000be35, 0x00003e35, 0x0000be35, 0x00003e35, 0xbe350000, 0x3e350000, 0xbe350000, 0x3e350000
.long 0xbe003e35, 0x3e000000, 0x3e00be35, 0xbe000000, 0x3e000000, 0x3e00be35, 0xbe000000, 0xbe003e35
.long 0x3e00be35, 0xbe000000, 0xbe003e35, 0x3e000000, 0xbe000000, 0xbe003e35, 0x3e000000, 0x3e00be35
.long 0x379e379e, 0x379e379e, 0x379e379e, 0x379e379e, 0x379e379e, 0x379e379e, 0x379e379e, 0x379e379e
.long 0x379e379e, 0x379e379e, 0x379e379e, 0x379e379e, 0x379e379e, 0x379e379e, 0x379e379e, 0x379e379e
.long 0x0000379e, 0x24000000, 0xa400b79e, 0xa4400000, 0x0000379e, 0x24000000, 0xa400b79e, 0xa4400000
.long 0x0000379e, 0x24000000, 0xa400b79e, 0xa4400000, 0x0000379e, 0x24000000, 0xa400b79e, 0xa4400000
.long 0x0000379e, 0x0000b79e, 0x0000379e, 0x0000b79e, 0x0000379e, 0x0000b79e, 0x0000379e, 0x0000b79e
.long 0x0000379e, 0x0000b79e, 0x0000379e, 0x0000b79e, 0x0000379e, 0x0000b79e, 0x0000379e, 0x0000b79e
.long 0x2400379e, 0x00000000, 0xa440b79e, 0xa4000000, 0x2400379e, 0x00000000, 0xa440b79e, 0xa4000000
.long 0x2400379e, 0x00000000, 0xa440b79e, 0xa4000000, 0x2400379e, 0x00000000, 0xa440b79e, 0xa4000000
.long 0x379e379e, 0x379e379e, 0x379e379e, 0x379e379e, 0xb79e379e, 0xb79e379e, 0xb79e379e, 0xb79e379e
.long 0xb79eb79e, 0xb79eb79e, 0xb79eb79e, 0xb79eb79e, 0x379eb79e, 0x379eb79e, 0x379eb79e, 0x379eb79e
.long 0x0000379e, 0x24000000, 0xa400b79e, 0xa4400000, 0x24000000, 0x0000b79e, 0xa4000000, 0x2400379e
.long 0xa400b79e, 0xa4400000, 0x2400379e, 0x24800000, 0xa4400000, 0x2400379e, 0x24400000, 0xa400b79e
.long 0x0000379e, 0x0000b79e, 0x0000379e, 0x0000b79e, 0xb79e0000, 0x379e0000, 0xb79e0000, 0x379e0000
.long 0x0000b79e, 0x0000379e, 0x0000b79e, 0x0000379e, 0x379e0000, 0xb79e0000, 0x379e0000, 0xb79e0000
.long 0x2400379e, 0x00000000, 0xa440b79e, 0xa4000000, 0x00000000, 0x2400379e, 0x24000000, 0xa400b79e
.long 0xa440b79e, 0xa4000000, 0x2480379e, 0x24000000, 0x24000000, 0xa440b79e, 0xa4000000, 0x2440379e
.long 0x379e379e, 0x379e379e, 0x379e379e, 0x379e379e, 0xb79eb79e, 0xb79eb79e, 0xb79eb79e, 0xb79eb79e
.long 0x379e379e, 0x379e379e, 0x379e379e, 0x379e379e, 0xb79eb79e, 0xb79eb79e, 0xb79eb79e, 0xb79eb79e
.long 0x0000379e, 0x24000000, 0xa400b79e, 0xa4400000, 0xa400b79e, 0xa4400000, 0x2400379e, 0x24800000
.long 0x0000379e, 0x24000000, 0xa400b79e, 0xa4400000, 0xa400b79e, 0xa4400000, 0x2400379e, 0x24800000
.long 0x0000379e, 0x0000b79e, 0x0000379e, 0x0000b79e, 0x0000b79e, 0x0000379e, 0x0000b79e, 0x0000379e
.long 0x0000379e, 0x0000b79e, 0x0000379e, 0x0000b79e, 0x0000b79e, 0x0000379e, 0x0000b79e, 0x0000379e
.long 0x2400379e, 0x00000000, 0xa440b79e, 0xa4000000, 0xa440b79e, 0xa4000000, 0x2480379e, 0x24000000
.long 0x2400379e, 0x00000000, 0xa440b79e, 0xa4000000, 0xa440b79e, 0xa4000000, 0x2480379e, 0x24000000
.long 0x379e379e, 0x379e379e, 0x379e379e, 0x379e379e, 0x379eb79e, 0x379eb79e, 0x379eb79e, 0x379eb79e
.long 0xb79eb79e, 0xb79eb79e, 0xb79eb79e, 0xb79eb79e, 0xb79e379e, 0xb79e379e, 0xb79e379e, 0xb79e379e
.long 0x0000379e, 0x24000000, 0xa400b79e, 0xa4400000, 0xa4400000, 0x2400379e, 0x24400000, 0xa400b79e
.long 0xa400b79e, 0xa4400000, 0x2400379e, 0x24800000, 0x24000000, 0x0000b79e, 0xa4000000, 0x2400379e
.long 0x0000379e, 0x0000b79e, 0x0000379e, 0x0000b79e, 0x379e0000, 0xb79e0000, 0x379e0000, 0xb79e0000
.long 0x0000b79e, 0x0000379e, 0x0000b79e, 0x0000379e, 0xb79e0000, 0x379e0000, 0xb79e0000, 0x379e0000
.long 0x2400379e, 0x00000000, 0xa440b79e, 0xa4000000, 0x24000000, 0xa440b79e, 0xa4000000, 0x2440379e
.long 0xa440b79e, 0xa4000000, 0x2480379e, 0x24000000, 0x00000000, 0x2400379e, 0x24000000, 0xa400b79e
.long 0xbe353e35, 0xbe353e35, 0xbe353e35, 0xbe353e35, 0xbe353e35, 0xbe353e35, 0xbe353e35, 0xbe353e35
.long 0xbe353e35, 0xbe353e35, 0xbe353e35, 0xbe353e35, 0xbe353e35, 0xbe353e35, 0xbe353e35, 0xbe353e35
.long 0xbe000000, 0xbe00be35, 0x3e000000, 0x3e003e35, 0xbe000000, 0xbe00be35, 0x3e000000, 0x3e003e35
.long 0xbe000000, 0xbe00be35, 0x3e000000, 0x3e003e35, 0xbe000000, 0xbe00be35, 0x3e000000, 0x3e003e35
.long 0xbe350000, 0x3e350000, 0xbe350000, 0x3e350000, 0xbe350000, 0x3e350000, 0xbe350000, 0x3e350000
.long 0xbe350000, 0x3e350000, 0xbe350000, 0x3e350000, 0xbe350000, 0x3e350000, 0xbe350000, 0x3e350000
.long 0xbe000000, 0xbe003e35, 0x3e000000, 0x3e00be35, 0xbe000000, 0xbe003e35, 0x3e000000, 0x3e00be35
.long 0xbe000000, 0xbe003e35, 0x3e000000, 0x3e00be35, 0xbe000000, 0xbe003e35, 0x3e000000, 0x3e00be35
.long 0xbe353e35, 0xbe353e35, 0xbe353e35, 0xbe353e35, 0xbe35be35, 0xbe35be35, 0xbe35be35, 0xbe35be35
.long 0x3e35be35, 0x3e35be35, 0x3e35be35, 0x3e35be35, 0x3e353e35, 0x3e353e35, 0x3e353e35, 0x3e353e35
.long 0xbe000000, 0xbe00be35, 0x3e000000, 0x3e003e35, 0xbe00be35, 0x3e000000, 0x3e003e35, 0xbe000000
.long 0x3e000000, 0x3e003e35, 0xbe000000, 0xbe00be35, 0x3e003e35, 0xbe000000, 0xbe00be35, 0x3e000000
.long 0xbe350000, 0x3e350000, 0xbe350000, 0x3e350000, 0x0000be35, 0x00003e35, 0x0000be35, 0x00003e35
.long 0x3e350000, 0xbe350000, 0x3e350000, 0xbe350000, 0x00003e35, 0x0000be35, 0x00003e35, 0x0000be35
.long 0xbe000000, 0xbe003e35, 0x3e000000, 0x3e00be35, 0x3e00be35, 0xbe000000, 0xbe003e35, 0x3e000000
.long 0x3e000000, 0x3e00be35, 0xbe000000, 0xbe003e35, 0xbe003e35, 0x3e000000, 0x3e00be35, 0xbe000000
.long 0xbe353e35, 0xbe353e35, 0xbe353e35, 0xbe353e35, 0x3e35be35, 0x3e35be35, 0x3e35be35, 0x3e35be35
.long 0xbe353e35, 0xbe353e35, 0xbe353e35, 0xbe353e35, 0x3e35be35, 0x3e35be35, 0x3e35be35, 0x3e35be35
.long 0xbe000000, 0xbe00be35, 0x3e000000, 0x3e003e35, 0x3e000000, 0x3e003e35, 0xbe000000, 0xbe00be35
.long 0xbe000000, 0xbe00be35, 0x3e000000, 0x3e003e35, 0x3e000000, 0x3e003e35, 0xbe000000, 0xbe00be35
.long 0xbe350000, 0x3e350000, 0xbe350000, 0x3e350000, 0x3e350000, 0xbe350000, 0x3e350000, 0xbe350000
.long 0xbe350000, 0x3e350000, 0xbe350000, 0x3e350000, 0x3e350000, 0xbe350000, 0x3e350000, 0xbe350000
.long 0xbe000000, 0xbe003e35, 0x3e000000, 0x3e00be35, 0x3e000000, 0x3e00be35, 0xbe000000, 0xbe003e35
.long 0xbe000000, 0xbe003e35, 0x3e000000, 0x3e00be35, 0x3e000000, 0x3e00be35, 0xbe000000, 0xbe003e35
.long 0xbe353e35, 0xbe353e35, 0xbe353e35, 0xbe353e35, 0x3e353e35, 0x3e353e35, 0x3e353e35, 0x3e353e35
.long 0x3e35be35, 0x3e35be35, 0x3e35be35, 0x3e35be35, 0xbe35be35, 0xbe35be35, 0xbe35be35, 0xbe35be35
.long 0xbe000000, 0xbe00be35, 0x3e000000, 0x3e003e35, 0x3e003e35, 0xbe000000, 0xbe00be35, 0x3e000000
.long 0x3e000000, 0x3e003e35, 0xbe000000, 0xbe00be35, 0xbe00be35, 0x3e000000, 0x3e003e35, 0xbe000000
.long 0xbe350000, 0x3e350000, 0xbe350000, 0x3e350000, 0x00003e35, 0x0000be35, 0x00003e35, 0x0000be35
.long 0x3e350000, 0xbe350000, 0x3e350000, 0xbe350000, 0x0000be35, 0x00003e35, 0x0000be35, 0x00003e35
.long 0xbe000000, 0xbe003e35, 0x3e000000, 0x3e00be35, 0xbe003e35, 0x3e000000, 0x3e00be35, 0xbe000000
.long 0x3e000000, 0x3e00be35, 0xbe000000, 0xbe003e35, 0x3e00be35, 0xbe000000, 0xbe003e35, 0x3e000000
.long 0xb79e379e, 0xb79e379e, 0xb79e379e, 0xb79e379e, 0xb79e379e, 0xb79e379e, 0xb79e379e, 0xb79e379e
.long 0xb79e379e, 0xb79e379e, 0xb79e379e, 0xb79e379e, 0xb79e379e, 0xb79e379e, 0xb79e379e, 0xb79e379e
.long 0x24000000, 0x0000b79e, 0xa4000000, 0x2400379e, 0x24000000, 0x0000b79e, 0xa4000000, 0x2400379e
.long 0x24000000, 0x0000b79e, 0xa4000000, 0x2400379e, 0x24000000, 0x0000b79e, 0xa4000000, 0x2400379e
.long 0xb79e0000, 0x379e0000, 0xb79e0000, 0x379e0000, 0xb79e0000, 0x379e0000, 0xb79e0000, 0x379e0000
.long 0xb79e0000, 0x379e0000, 0xb79e0000, 0x379e0000, 0xb79e0000, 0x379e0000, 0xb79e0000, 0x379e0000
.long 0x00000000, 0x2400379e, 0x24000000, 0xa400b79e, 0x00000000, 0x2400379e, 0x24000000, 0xa400b79e
.long 0x00000000, 0x2400379e, 0x24000000, 0xa400b79e, 0x00000000, 0x2400379e, 0x24000000, 0xa400b79e
.long 0xb79e379e, 0xb79e379e, 0xb79e379e, 0xb79e379e, 0xb79eb79e, 0xb79eb79e, 0xb79eb79e, 0xb79eb79e
.long 0x379eb79e, 0x379eb79e, 0x379eb79e, 0x379eb79e, 0x379e379e, 0x379e379e, 0x379e379e, 0x379e379e
.long 0x24000000, 0x0000b79e, 0xa4000000, 0x2400379e, 0x0000b79e, 0xa4000000, 0x2400379e, 0x24400000
.long 0xa4400000, 0x2400379e, 0x24400000, 0xa400b79e, 0x2400379e, 0x24400000, 0xa400b79e, 0xa4800000
.long 0xb79e0000, 0x379e0000, 0xb79e0000, 0x379e0000, 0x0000b79e, 0x0000379e, 0x0000b79e, 0x0000379e
.long 0x379e0000, 0xb79e0000, 0x379e0000, 0xb79e0000, 0x0000379e, 0x0000b79e, 0x0000379e, 0x0000b79e
.long 0x00000000, 0x2400379e, 0x24000000, 0xa400b79e, 0xa400b79e, 0x00000000, 0x2440379e, 0x24000000
.long 0x24000000, 0xa440b79e, 0xa4000000, 0x2440379e, 0x2440379e, 0x24000000, 0xa480b79e, 0xa4000000
.long 0xb79e379e, 0xb79e379e, 0xb79e379e, 0xb79e379e, 0x379eb79e, 0x379eb79e, 0x379eb79e, 0x379eb79e
.long 0xb79e379e, 0xb79e379e, 0xb79e379e, 0xb79e379e, 0x379eb79e, 0x379eb79e, 0x379eb79e, 0x379eb79e
.long 0x24000000, 0x0000b79e, 0xa4000000, 0x2400379e, 0xa4400000, 0x2400379e, 0x24400000, 0xa400b79e
.long 0x24000000, 0x0000b79e, 0xa4000000, 0x2400379e, 0xa4400000, 0x2400379e, 0x24400000, 0xa400b79e
.long 0xb79e0000, 0x379e0000, 0xb79e0000, 0x379e0000, 0x379e0000, 0xb79e0000, 0x379e0000, 0xb79e0000
.long 0xb79e0000, 0x379e0000, 0xb79e0000, 0x379e0000, 0x379e0000, 0xb79e0000, 0x379e0000, 0xb79e0000
.long 0x00000000, 0x2400379e, 0x24000000, 0xa400b79e, 0x24000000, 0xa440b79e, 0xa4000000, 0x2440379e
.long 0x00000000, 0x2400379e, 0x24000000, 0xa400b79e, 0x24000000, 0xa440b79e, 0xa4000000, 0x2440379e
.long 0xb79e379e, 0xb79e379e, 0xb79e379e, 0xb79e379e, 0x379e379e, 0x379e379e, 0x379e379e, 0x379e379e
.long 0x379eb79e, 0x379eb79e, 0x379eb79e, 0x379eb79e, 0xb79eb79e, 0xb79eb79e, 0xb79eb79e, 0xb79eb79e
.long 0x24000000, 0x0000b79e, 0xa4000000, 0x2400379e, 0x2400379e, 0x24400000, 0xa400b79e, 0xa4800000
.long 0xa4400000, 0x2400379e, 0x24400000, 0xa400b79e, 0x0000b79e, 0xa4000000, 0x2400379e, 0x24400000
.long 0xb79e0000, 0x379e0000, 0xb79e0000, 0x379e0000, 0x0000379e, 0x0000b79e, 0x0000379e, 0x0000b79e
.long 0x379e0000, 0xb79e0000, 0x379e0000, 0xb79e0000, 0x0000b79e, 0x0000379e, 0x0000b79e, 0x0000379e
.long 0x00000000, 0x2400379e, 0x24000000, 0xa400b79e, 0x2440379e, 0x24000000, 0xa480b79e, 0xa4000000
.long 0x24000000, 0xa440b79e, 0xa4000000, 0x2440379e, 0xa400b79e, 0x00000000, 0x2440379e, 0x24000000
.long 0x00003400, 0x00003400, 0x00003400, 0x00003400, 0x34000000, 0x34000000, 0x34000000, 0x34000000
.long 0x00003400, 0x2e1f3364, 0x31a831a8, 0x33642e1f, 0x34000000, 0x3364ae1f, 0x31a8b1a8, 0x2e1fb364
.long 0x00003400, 0x31a831a8, 0x34000000, 0x31a8b1a8, 0x34000000, 0x31a8b1a8, 0x0000b400, 0xb1a8b1a8
.long 0x00003400, 0x33642e1f, 0x31a8b1a8, 0xae1fb364, 0x34000000, 0x2e1fb364, 0xb1a8b1a8, 0xb3642e1f
.long 0x00003400, 0x34000000, 0x0000b400, 0xb4000000, 0x34000000, 0x0000b400, 0xb4000000, 0x00003400
.long 0x00003400, 0x3364ae1f, 0xb1a8b1a8, 0xae1f3364, 0x34000000, 0xae1fb364, 0xb1a831a8, 0x33642e1f
.long 0x00003400, 0x31a8b1a8, 0xb4000000, 0x31a831a8, 0x34000000, 0xb1a8b1a8, 0x00003400, 0x31a8b1a8
.long 0x00003400, 0x2e1fb364, 0xb1a831a8, 0x3364ae1f, 0x34000000, 0xb364ae1f, 0x31a831a8, 0xae1fb364
.long 0x00003400, 0x00003400, 0x00003400, 0x00003400, 0x34000000, 0x34000000, 0x34000000, 0x34000000
.long 0x34000000, 0x3364ae1f, 0x31a8b1a8, 0x2e1fb364, 0x0000b400, 0xae1fb364, 0xb1a8b1a8, 0xb364ae1f
.long 0x0000b400, 0xb1a8b1a8, 0xb4000000, 0xb1a831a8, 0xb4000000, 0xb1a831a8, 0x00003400, 0x31a831a8
.long 0xb4000000, 0xae1f3364, 0x31a831a8, 0x3364ae1f, 0x00003400, 0x33642e1f, 0x31a8b1a8, 0xae1fb364
.long 0x00003400, 0x34000000, 0x0000b400, 0xb4000000, 0x34000000, 0x0000b400, 0xb4000000, 0x00003400
.long 0x34000000, 0xae1fb364, 0xb1a831a8, 0x33642e1f, 0x0000b400, 0xb3642e1f, 0x31a831a8, 0x2e1fb364
.long 0x0000b400, 0xb1a831a8, 0x34000000, 0xb1a8b1a8, 0xb4000000, 0x31a831a8, 0x0000b400, 0xb1a831a8
.long 0xb4000000, 0x33642e1f, 0xb1a8b1a8, 0x2e1f3364, 0x00003400, 0x2e1fb364, 0xb1a831a8, 0x3364ae1f
.long 0x00003400, 0x00003400, 0x00003400, 0x00003400, 0x34000000, 0x34000000, 0x34000000, 0x34000000
.long 0x0000b400, 0xae1fb364, 0xb1a8b1a8, 0xb364ae1f, 0xb4000000, 0xb3642e1f, 0xb1a831a8, 0xae1f3364
.long 0x00003400, 0x31a831a8, 0x34000000, 0x31a8b1a8, 0x34000000, 0x31a8b1a8, 0x0000b400, 0xb1a8b1a8
.long 0x0000b400, 0xb364ae1f, 0xb1a831a8, 0x2e1f3364, 0xb4000000, 0xae1f3364, 0x31a831a8, 0x3364ae1f
.long 0x00003400, 0x34000000, 0x0000b400, 0xb4000000, 0x34000000, 0x0000b400, 0xb4000000, 0x00003400
.long 0x0000b400, 0xb3642e1f, 0x31a831a8, 0x2e1fb364, 0xb4000000, 0x2e1f3364, 0x31a8b1a8, 0xb364ae1f
.long 0x00003400, 0x31a8b1a8, 0xb4000000, 0x31a831a8, 0x34000000, 0xb1a8b1a8, 0x00003400, 0x31a8b1a8
.long 0x0000b400, 0xae1f3364, 0x31a8b1a8, 0xb3642e1f, 0xb4000000, 0x33642e1f, 0xb1a8b1a8, 0x2e1f3364
.long 0x00003400, 0x00003400, 0x00003400, 0x00003400, 0x34000000, 0x34000000, 0x34000000, 0x34000000
.long 0xb4000000, 0xb3642e1f, 0xb1a831a8, 0xae1f3364, 0x00003400, 0x2e1f3364, 0x31a831a8, 0x33642e1f
.long 0x0000b400, 0xb1a8b1a8, 0xb4000000, 0xb1a831a8, 0xb4000000, 0xb1a831a8, 0x00003400, 0x31a831a8
.long 0x34000000, 0x2e1fb364, 0xb1a8b1a8, 0xb3642e1f, 0x0000b400, 0xb364ae1f, 0xb1a831a8, 0x2e1f3364
.long 0x00003400, 0x34000000, 0x0000b400, 0xb4000000, 0x34000000, 0x0000b400, 0xb4000000, 0x00003400
.long 0xb4000000, 0x2e1f3364, 0x31a8b1a8, 0xb364ae1f, 0x00003400, 0x3364ae1f, 0xb1a8b1a8, 0xae1f3364
.long 0x0000b400, 0xb1a831a8, 0x34000000, 0xb1a8b1a8, 0xb4000000, 0x31a831a8, 0x0000b400, 0xb1a831a8
.long 0x34000000, 0xb364ae1f, 0x31a831a8, 0xae1fb364, 0x0000b400, 0xae1f3364, 0x31a8b1a8, 0xb3642e1f
.long 0x00003400, 0x0000b400, 0x00003400, 0x0000b400, 0x34000000, 0xb4000000, 0x34000000, 0xb4000000
.long 0x00003400, 0xae1fb364, 0x31a831a8, 0xb364ae1f, 0x34000000, 0xb3642e1f, 0x31a8b1a8, 0xae1f3364
.long 0x00003400, 0xb1a8b1a8, 0x34000000, 0xb1a831a8, 0x34000000, 0xb1a831a8, 0x0000b400, 0x31a831a8
.long 0x00003400, 0xb364ae1f, 0x31a8b1a8, 0x2e1f3364, 0x34000000, 0xae1f3364, 0xb1a8b1a8, 0x3364ae1f
.long 0x00003400, 0xb4000000, 0x0000b400, 0x34000000, 0x34000000, 0x00003400, 0xb4000000, 0x0000b400
.long 0x00003400, 0xb3642e1f, 0xb1a8b1a8, 0x2e1fb364, 0x34000000, 0x2e1f3364, 0xb1a831a8, 0xb364ae1f
.long 0x00003400, 0xb1a831a8, 0xb4000000, 0xb1a8b1a8, 0x34000000, 0x31a831a8, 0x00003400, 0xb1a831a8
.long 0x00003400, 0xae1f3364, 0xb1a831a8, 0xb3642e1f, 0x34000000, 0x33642e1f, 0x31a831a8, 0x2e1f3364
.long 0x00003400, 0x0000b400, 0x00003400, 0x0000b400, 0x34000000, 0xb4000000, 0x34000000, 0xb4000000
.long 0x34000000, 0xb3642e1f, 0x31a8b1a8, 0xae1f3364, 0x0000b400, 0x2e1f3364, 0xb1a8b1a8, 0x33642e1f
.long 0x0000b400, 0x31a831a8, 0xb4000000, 0x31a8b1a8, 0xb4000000, 0x31a8b1a8, 0x00003400, 0xb1a8b1a8
.long 0xb4000000, 0x2e1fb364, 0x31a831a8, 0xb3642e1f, 0x00003400, 0xb364ae1f, 0x31a8b1a8, 0x2e1f3364
.long 0x00003400, 0xb4000000, 0x0000b400, 0x34000000, 0x34000000, 0x00003400, 0xb4000000, 0x0000b400
.long 0x34000000, 0x2e1f3364, 0xb1a831a8, 0xb364ae1f, 0x0000b400, 0x3364ae1f, 0x31a831a8, 0xae1f3364
.long 0x0000b400, 0x31a8b1a8, 0x34000000, 0x31a831a8, 0xb4000000, 0xb1a8b1a8, 0x0000b400, 0x31a8b1a8
.long 0xb4000000, 0xb364ae1f, 0xb1a8b1a8, 0xae1fb364, 0x00003400, 0xae1f3364, 0xb1a831a8, 0xb3642e1f
.long 0x00003400, 0x0000b400, 0x00003400, 0x0000b400, 0x34000000, 0xb4000000, 0x34000000, 0xb4000000
.long 0x0000b400, 0x2e1f3364, 0xb1a8b1a8, 0x33642e1f, 0xb4000000, 0x3364ae1f, 0xb1a831a8, 0x2e1fb364
.long 0x00003400, 0xb1a8b1a8, 0x34000000, 0xb1a831a8, 0x34000000, 0xb1a831a8, 0x0000b400, 0x31a831a8
.long 0x0000b400, 0x33642e1f, 0xb1a831a8, 0xae1fb364, 0xb4000000, 0x2e1fb364, 0x31a831a8, 0xb3642e1f
.long 0x00003400, 0xb4000000, 0x0000b400, 0x34000000, 0x34000000, 0x00003400, 0xb4000000, 0x0000b400
.long 0x0000b400, 0x3364ae1f, 0x31a831a8, 0xae1f3364, 0xb4000000, 0xae1fb364, 0x31a8b1a8, 0x33642e1f
.long 0x00003400, 0xb1a831a8, 0xb4000000, 0xb1a8b1a8, 0x34000000, 0x31a831a8, 0x00003400, 0xb1a831a8
.long 0x0000b400, 0x2e1fb364, 0x31a8b1a8, 0x3364ae1f, 0xb4000000, 0xb364ae1f, 0xb1a8b1a8, 0xae1fb364
.long 0x00003400, 0x0000b400, 0x00003400, 0x0000b400, 0x34000000, 0xb4000000, 0x34000000, 0xb4000000
.long 0xb4000000, 0x3364ae1f, 0xb1a831a8, 0x2e1fb364, 0x00003400, 0xae1fb364, 0x31a831a8, 0xb364ae1f
.long 0x0000b400, 0x31a831a8, 0xb4000000, 0x31a8b1a8, 0xb4000000, 0x31a8b1a8, 0x00003400, 0xb1a8b1a8
.long 0x34000000, 0xae1f3364, 0xb1a8b1a8, 0x3364ae1f, 0x0000b400, 0x33642e1f, 0xb1a831a8, 0xae1fb364
.long 0x00003400, 0xb4000000, 0x0000b400, 0x34000000, 0x34000000, 0x00003400, 0xb4000000, 0x0000b400
.long 0xb4000000, 0xae1fb364, 0x31a8b1a8, 0x33642e1f, 0x00003400, 0xb3642e1f, 0xb1a8b1a8, 0x2e1fb364
.long 0x0000b400, 0x31a8b1a8, 0x34000000, 0x31a831a8, 0xb4000000, 0xb1a8b1a8, 0x0000b400, 0x31a8b1a8
.long 0x34000000, 0x33642e1f, 0x31a831a8, 0x2e1f3364, 0x0000b400, 0x2e1fb364, 0x31a8b1a8, 0x3364ae1f
.long 0x3f800000, 0x3f800000, 0x3f800000, 0x3f800000, 0x3f800000, 0x3f7ec46d, 0x3f7b14be, 0x3f74fa0b
.long 0x3f800000, 0x3f7b14be, 0x3f6c835e, 0x3f54db31, 0x3f800000, 0x3f74fa0b, 0x3f54db31, 0x3f226799
.long 0x3f800000, 0x3f800000, 0x3f800000, 0x3f800000, 0x3f800000, 0x3f7ec46d, 0x3f7b14be, 0x3f74fa0b
.long 0x3f800000, 0x3f7b14be, 0x3f6c835e, 0x3f54db31, 0x3f800000, 0x3f74fa0b, 0x3f54db31, 0x3f226799
.long 0x3f800000, 0x3f800000, 0x3f800000, 0x3f800000, 0x3f800000, 0x3f7ec46d, 0x3f7b14be, 0x3f74fa0b
.long 0x3f800000, 0x3f7b14be, 0x3f6c835e, 0x3f54db31, 0x3f800000, 0x3f74fa0b, 0x3f54db31, 0x3f226799
.long 0x3f800000, 0x3f800000, 0x3f800000, 0x3f800000, 0x3f800000, 0x3f7ec46d, 0x3f7b14be, 0x3f74fa0b
.long 0x3f800000, 0x3f7b14be, 0x3f6c835e, 0x3f54db31, 0x3f800000, 0x3f74fa0b, 0x3f54db31, 0x3f226799
.long 0x3f800000, 0x3f800000, 0x3f800000, 0x3f800000, 0x3f6c835e, 0x3f61c598, 0x3f54db31, 0x3f45e403
.long 0x3f3504f3, 0x3f0e39da, 0x3ec3ef15, 0x3e47c5c2, 0x3ec3ef15, 0x3dc8bd36, 0xbe47c5c2, 0xbef15aea
.long 0x3f800000, 0x3f800000, 0x3f800000, 0x3f800000, 0x3f6c835e, 0x3f61c598, 0x3f54db31, 0x3f45e403
.long 0x3f3504f3, 0x3f0e39da, 0x3ec3ef15, 0x3e47c5c2, 0x3ec3ef15, 0x3dc8bd36, 0xbe47c5c2, 0xbef15aea
.long 0x3f800000, 0x3f800000, 0x3f800000, 0x3f800000, 0x3f6c835e, 0x3f61c598, 0x3f54db31, 0x3f45e403
.long 0x3f3504f3, 0x3f0e39da, 0x3ec3ef15, 0x3e47c5c2, 0x3ec3ef15, 0x3dc8bd36, 0xbe47c5c2, 0xbef15aea
.long 0x3f800000, 0x3f800000, 0x3f800000, 0x3f800000, 0x3f6c835e, 0x3f61c598, 0x3f54db31, 0x3f45e403
.long 0x3f3504f3, 0x3f0e39da, 0x3ec3ef15, 0x3e47c5c2, 0x3ec3ef15, 0x3dc8bd36, 0xbe47c5c2, 0xbef15aea
.long 0x3f800000, 0x3f800000, 0x3f800000, 0x3f800000, 0x3f3504f3, 0x3f226799, 0x3f0e39da, 0x3ef15aea
.long 0x00000000, 0xbe47c5c2, 0xbec3ef15, 0xbf0e39da, 0xbf3504f3, 0xbf61c598, 0xbf7b14be, 0xbf7ec46d
.long 0x3f800000, 0x3f800000, 0x3f800000, 0x3f800000, 0x3f3504f3, 0x3f226799, 0x3f0e39da, 0x3ef15aea
.long 0x00000000, 0xbe47c5c2, 0xbec3ef15, 0xbf0e39da, 0xbf3504f3, 0xbf61c598, 0xbf7b14be, 0xbf7ec46d
.long 0x3f800000, 0x3f800000, 0x3f800000, 0x3f800000, 0x3f3504f3, 0x3f226799, 0x3f0e39da, 0x3ef15aea
.long 0x00000000, 0xbe47c5c2, 0xbec3ef15, 0xbf0e39da, 0xbf3504f3, 0xbf61c598, 0xbf7b14be, 0xbf7ec46d
.long 0x3f800000, 0x3f800000, 0x3f800000, 0x3f800000, 0x3f3504f3, 0x3f226799, 0x3f0e39da, 0x3ef15aea
.long 0x00000000, 0xbe47c5c2, 0xbec3ef15, 0xbf0e39da, 0xbf3504f3, 0xbf61c598, 0xbf7b14be, 0xbf7ec46d
.long 0x3f800000, 0x3f800000, 0x3f800000, 0x3f800000, 0x3ec3ef15, 0x3e94a031, 0x3e47c5c2, 0x3dc8bd36
.long 0xbf3504f3, 0xbf54db31, 0xbf6c835e, 0xbf7b14be, 0xbf6c835e, 0xbf45e403, 0xbf0e39da, 0xbe94a031
.long 0x3f800000, 0x3f800000, 0x3f800000, 0x3f800000, 0x3ec3ef15, 0x3e94a031, 0x3e47c5c2, 0x3dc8bd36
.long 0xbf3504f3, 0xbf54db31, 0xbf6c835e, 0xbf7b14be, 0xbf6c835e, 0xbf45e403, 0xbf0e39da, 0xbe94a031
.long 0x3f800000, 0x3f800000, 0x3f800000, 0x3f800000, 0x3ec3ef15, 0x3e94a031, 0x3e47c5c2, 0x3dc8bd36
.long 0xbf3504f3, 0xbf54db31, 0xbf6c835e, 0xbf7b14be, 0xbf6c835e, 0xbf45e403, 0xbf0e39da, 0xbe94a031
.long 0x3f800000, 0x3f800000, 0x3f800000, 0x3f800000, 0x3ec3ef15, 0x3e94a031, 0x3e47c5c2, 0x3dc8bd36
.long 0xbf3504f3, 0xbf54db31, 0xbf6c835e, 0xbf7b14be, 0xbf6c835e, 0xbf45e403, 0xbf0e39da, 0xbe94a031
.long 0x00000000, 0x00000000, 0x00000000, 0x00000000, 0x00000000, 0xbdc8bd36, 0xbe47c5c2, 0xbe94a031
.long 0x00000000, 0xbe47c5c2, 0xbec3ef15, 0xbf0e39da, 0x00000000, 0xbe94a031, 0xbf0e39da, 0xbf45e403
.long 0x00000000, 0x00000000, 0x00000000, 0x00000000, 0x00000000, 0xbdc8bd36, 0xbe47c5c2, 0xbe94a031
.long 0x00000000, 0xbe47c5c2, 0xbec3ef15, 0xbf0e39da, 0x00000000, 0xbe94a031, 0xbf0e39da, 0xbf45e403
.long 0x00000000, 0x00000000, 0x00000000, 0x00000000, 0x00000000, 0xbdc8bd36, 0xbe47c5c2, 0xbe94a031
.long 0x00000000, 0xbe47c5c2, 0xbec3ef15, 0xbf0e39da, 0x00000000, 0xbe94a031, 0xbf0e39da, 0xbf45e403
.long 0x00000000, 0x00000000, 0x00000000, 0x00000000, 0x00000000, 0xbdc8bd36, 0xbe47c5c2, 0xbe94a031
.long 0x00000000, 0xbe47c5c2, 0xbec3ef15, 0xbf0e39da, 0x00000000, 0xbe94a031, 0xbf0e39da, 0xbf45e403
.long 0x00000000, 0x00000000, 0x00000000, 0x00000000, 0xbec3ef15, 0xbef15aea, 0xbf0e39da, 0xbf226799
.long 0xbf3504f3, 0xbf54db31, 0xbf6c835e, 0xbf7b14be, 0xbf6c835e, 0xbf7ec46d, 0xbf7b14be, 0xbf61c598
.long 0x00000000, 0x00000000, 0x00000000, 0x00000000, 0xbec3ef15, 0xbef15aea, 0xbf0e39da, 0xbf226799
.long 0xbf3504f3, 0xbf54db31, 0xbf6c835e, 0xbf7b14be, 0xbf6c835e, 0xbf7ec46d, 0xbf7b14be, 0xbf61c598
.long 0x00000000, 0x00000000, 0x00000000, 0x00000000, 0xbec3ef15, 0xbef15aea, 0xbf0e39da, 0xbf226799
.long 0xbf3504f3, 0xbf54db31, 0xbf6c835e, 0xbf7b14be, 0xbf6c835e, 0xbf7ec46d, 0xbf7b14be, 0xbf61c598
.long 0x00000000, 0x00000000, 0x00000000, 0x00000000, 0xbec3ef15, 0xbef15aea, 0xbf0e39da, 0xbf226799
.long 0xbf3504f3, 0xbf54db31, 0xbf6c835e, 0xbf7b14be, 0xbf6c835e, 0xbf7ec46d, 0xbf7b14be, 0xbf61c598
.long 0x00000000, 0x00000000, 0x00000000, 0x00000000, 0xbf3504f3, 0xbf45e403, 0xbf54db31, 0xbf61c598
.long 0xbf800000, 0xbf7b14be, 0xbf6c835e, 0xbf54db31, 0xbf3504f3, 0xbef15aea, 0xbe47c5c2, 0x3dc8bd36
.long 0x00000000, 0x00000000, 0x00000000, 0x00000000, 0xbf3504f3, 0xbf45e403, 0xbf54db31, 0xbf61c598
.long 0xbf800000, 0xbf7b14be, 0xbf6c835e, 0xbf54db31, 0xbf3504f3, 0xbef15aea, 0xbe47c5c2, 0x3dc8bd36
.long 0x00000000, 0x00000000, 0x00000000, 0x00000000, 0xbf3504f3, 0xbf45e403, 0xbf54db31, 0xbf61c598
.long 0xbf800000, 0xbf7b14be, 0xbf6c835e, 0xbf54db31, 0xbf3504f3, 0xbef15aea, 0xbe47c5c2, 0x3dc8bd36
.long 0x00000000, 0x00000000, 0x00000000, 0x00000000, 0xbf3504f3, 0xbf45e403, 0xbf54db31, 0xbf61c598
.long 0xbf800000, 0xbf7b14be, 0xbf6c835e, 0xbf54db31, 0xbf3504f3, 0xbef15aea, 0xbe47c5c2, 0x3dc8bd36
.long 0x00000000, 0x00000000, 0x00000000, 0x00000000, 0xbf6c835e, 0xbf74fa0b, 0xbf7b14be, 0xbf7ec46d
.long 0xbf3504f3, 0xbf0e39da, 0xbec3ef15, 0xbe47c5c2, 0x3ec3ef15, 0x3f226799, 0x3f54db31, 0x3f74fa0b
.long 0x00000000, 0x00000000, 0x00000000, 0x00000000, 0xbf6c835e, 0xbf74fa0b, 0xbf7b14be, 0xbf7ec46d
.long 0xbf3504f3, 0xbf0e39da, 0xbec3ef15, 0xbe47c5c2, 0x3ec3ef15, 0x3f226799, 0x3f54db31, 0x3f74fa0b
.long 0x00000000, 0x00000000, 0x00000000, 0x00000000, 0xbf6c835e, 0xbf74fa0b, 0xbf7b14be, 0xbf7ec46d
.long 0xbf3504f3, 0xbf0e39da, 0xbec3ef15, 0xbe47c5c2, 0x3ec3ef15, 0x3f226799, 0x3f54db31, 0x3f74fa0b
.long 0x00000000, 0x00000000, 0x00000000, 0x00000000, 0xbf6c835e, 0xbf74fa0b, 0xbf7b14be, 0xbf7ec46d
.long 0xbf3504f3, 0xbf0e39da, 0xbec3ef15, 0xbe47c5c2, 0x3ec3ef15, 0x3f226799, 0x3f54db31, 0x3f74fa0b
.long 0x00003400, 0x00003400, 0x00003400, 0x00003400, 0x00003400, 0x2e1f3364, 0x31a831a8, 0x33642e1f
.long 0x00003400, 0x31a831a8, 0x34000000, 0x31a8b1a8, 0x00003400, 0x33642e1f, 0x31a8b1a8, 0xae1fb364
.long 0x00003400, 0x34000000, 0x0000b400, 0xb4000000, 0x00003400, 0x3364ae1f, 0xb1a8b1a8, 0xae1f3364
.long 0x00003400, 0x31a8b1a8, 0xb4000000, 0x31a831a8, 0x00003400, 0x2e1fb364, 0xb1a831a8, 0x3364ae1f
.long 0x00003400, 0x0000b400, 0x00003400, 0x0000b400, 0x00003400, 0xae1fb364, 0x31a831a8, 0xb364ae1f
.long 0x00003400, 0xb1a8b1a8, 0x34000000, 0xb1a831a8, 0x00003400, 0xb364ae1f, 0x31a8b1a8, 0x2e1f3364
.long 0x00003400, 0xb4000000, 0x0000b400, 0x34000000, 0x00003400, 0xb3642e1f, 0xb1a8b1a8, 0x2e1fb364
.long 0x00003400, 0xb1a831a8, 0xb4000000, 0xb1a8b1a8, 0x00003400, 0xae1f3364, 0xb1a831a8, 0xb3642e1f
.long 0x00003400, 0x00003400, 0x00003400, 0x00003400, 0x34000000, 0x3364ae1f, 0x31a8b1a8, 0x2e1fb364
.long 0x0000b400, 0xb1a8b1a8, 0xb4000000, 0xb1a831a8, 0xb4000000, 0xae1f3364, 0x31a831a8, 0x3364ae1f
.long 0x00003400, 0x34000000, 0x0000b400, 0xb4000000, 0x34000000, 0xae1fb364, 0xb1a831a8, 0x33642e1f
.long 0x0000b400, 0xb1a831a8, 0x34000000, 0xb1a8b1a8, 0xb4000000, 0x33642e1f, 0xb1a8b1a8, 0x2e1f3364
.long 0x00003400, 0x0000b400, 0x00003400, 0x0000b400, 0x34000000, 0xb3642e1f, 0x31a8b1a8, 0xae1f3364
.long 0x0000b400, 0x31a831a8, 0xb4000000, 0x31a8b1a8, 0xb4000000, 0x2e1fb364, 0x31a831a8, 0xb3642e1f
.long 0x00003400, 0xb4000000, 0x0000b400, 0x34000000, 0x34000000, 0x2e1f3364, 0xb1a831a8, 0xb364ae1f
.long 0x0000b400, 0x31a8b1a8, 0x34000000, 0x31a831a8, 0xb4000000, 0xb364ae1f, 0xb1a8b1a8, 0xae1fb364
.long 0x00003400, 0x00003400, 0x00003400, 0x00003400, 0x0000b400, 0xae1fb364, 0xb1a8b1a8, 0xb364ae1f
.long 0x00003400, 0x31a831a8, 0x34000000, 0x31a8b1a8, 0x0000b400, 0xb364ae1f, 0xb1a831a8, 0x2e1f3364
.long 0x00003400, 0x34000000, 0x0000b400, 0xb4000000, 0x0000b400, 0xb3642e1f, 0x31a831a8, 0x2e1fb364
.long 0x00003400, 0x31a8b1a8, 0xb4000000, 0x31a831a8, 0x0000b400, 0xae1f3364, 0x31a8b1a8, 0xb3642e1f
.long 0x00003400, 0x0000b400, 0x00003400, 0x0000b400, 0x0000b400, 0x2e1f3364, 0xb1a8b1a8, 0x33642e1f
.long 0x00003400, 0xb1a8b1a8, 0x34000000, 0xb1a831a8, 0x0000b400, 0x33642e1f, 0xb1a831a8, 0xae1fb364
.long 0x00003400, 0xb4000000, 0x0000b400, 0x34000000, 0x0000b400, 0x3364ae1f, 0x31a831a8, 0xae1f3364
.long 0x00003400, 0xb1a831a8, 0xb4000000, 0xb1a8b1a8, 0x0000b400, 0x2e1fb364, 0x31a8b1a8, 0x3364ae1f
.long 0x00003400, 0x00003400, 0x00003400, 0x00003400, 0xb4000000, 0xb3642e1f, 0xb1a831a8, 0xae1f3364
.long 0x0000b400, 0xb1a8b1a8, 0xb4000000, 0xb1a831a8, 0x34000000, 0x2e1fb364, 0xb1a8b1a8, 0xb3642e1f
.long 0x00003400, 0x34000000, 0x0000b400, 0xb4000000, 0xb4000000, 0x2e1f3364, 0x31a8b1a8, 0xb364ae1f
.long 0x0000b400, 0xb1a831a8, 0x34000000, 0xb1a8b1a8, 0x34000000, 0xb364ae1f, 0x31a831a8, 0xae1fb364
.long 0x00003400, 0x0000b400, 0x00003400, 0x0000b400, 0xb4000000, 0x3364ae1f, 0xb1a831a8, 0x2e1fb364
.long 0x0000b400, 0x31a831a8, 0xb4000000, 0x31a8b1a8, 0x34000000, 0xae1f3364, 0xb1a8b1a8, 0x3364ae1f
.long 0x00003400, 0xb4000000, 0x0000b400, 0x34000000, 0xb4000000, 0xae1fb364, 0x31a8b1a8, 0x33642e1f
.long 0x0000b400, 0x31a8b1a8, 0x34000000, 0x31a831a8, 0x34000000, 0x33642e1f, 0x31a831a8, 0x2e1f3364
.long 0x34008000, 0x34008000, 0x34008000, 0x34008000, 0x34008000, 0x3364ae1f, 0x31a8b1a8, 0x2e1fb364
.long 0x34008000, 0x31a8b1a8, 0x0000b400, 0xb1a8b1a8, 0x34008000, 0x2e1fb364, 0xb1a8b1a8, 0xb3642e1f
.long 0x34008000, 0x0000b400, 0xb4008000, 0x00003400, 0x34008000, 0xae1fb364, 0xb1a831a8, 0x33642e1f
.long 0x34008000, 0xb1a8b1a8, 0x00003400, 0x31a8b1a8, 0x34008000, 0xb364ae1f, 0x31a831a8, 0xae1fb364
.long 0x34008000, 0xb4008000, 0x34008000, 0xb4008000, 0x34008000, 0xb3642e1f, 0x31a8b1a8, 0xae1f3364
.long 0x34008000, 0xb1a831a8, 0x0000b400, 0x31a831a8, 0x34008000, 0xae1f3364, 0xb1a8b1a8, 0x3364ae1f
.long 0x34008000, 0x00003400, 0xb4008000, 0x0000b400, 0x34008000, 0x2e1f3364, 0xb1a831a8, 0xb364ae1f
.long 0x34008000, 0x31a831a8, 0x00003400, 0xb1a831a8, 0x34008000, 0x33642e1f, 0x31a831a8, 0x2e1f3364
.long 0x34008000, 0x34008000, 0x34008000, 0x34008000, 0x0000b400, 0xae1fb364, 0xb1a8b1a8, 0xb364ae1f
.long 0xb4008000, 0xb1a831a8, 0x00003400, 0x31a831a8, 0x00003400, 0x33642e1f, 0x31a8b1a8, 0xae1fb364
.long 0x34008000, 0x0000b400, 0xb4008000, 0x00003400, 0x0000b400, 0xb3642e1f, 0x31a831a8, 0x2e1fb364
.long 0xb4008000, 0x31a831a8, 0x0000b400, 0xb1a831a8, 0x00003400, 0x2e1fb364, 0xb1a831a8, 0x3364ae1f
.long 0x34008000, 0xb4008000, 0x34008000, 0xb4008000, 0x0000b400, 0x2e1f3364, 0xb1a8b1a8, 0x33642e1f
.long 0xb4008000, 0x31a8b1a8, 0x00003400, 0xb1a8b1a8, 0x00003400, 0xb364ae1f, 0x31a8b1a8, 0x2e1f3364
.long 0x34008000, 0x00003400, 0xb4008000, 0x0000b400, 0x0000b400, 0x3364ae1f, 0x31a831a8, 0xae1f3364
.long 0xb4008000, 0xb1a8b1a8, 0x0000b400, 0x31a8b1a8, 0x00003400, 0xae1f3364, 0xb1a831a8, 0xb3642e1f
.long 0x34008000, 0x34008000, 0x34008000, 0x34008000, 0xb4008000, 0xb3642e1f, 0xb1a831a8, 0xae1f3364
.long 0x34008000, 0x31a8b1a8, 0x0000b400, 0xb1a8b1a8, 0xb4008000, 0xae1f3364, 0x31a831a8, 0x3364ae1f
.long 0x34008000, 0x0000b400, 0xb4008000, 0x00003400, 0xb4008000, 0x2e1f3364, 0x31a8b1a8, 0xb364ae1f
.long 0x34008000, 0xb1a8b1a8, 0x00003400, 0x31a8b1a8, 0xb4008000, 0x33642e1f, 0xb1a8b1a8, 0x2e1f3364
.long 0x34008000, 0xb4008000, 0x34008000, 0xb4008000, 0xb4008000, 0x3364ae1f, 0xb1a831a8, 0x2e1fb364
.long 0x34008000, 0xb1a831a8, 0x0000b400, 0x31a831a8, 0xb4008000, 0x2e1fb364, 0x31a831a8, 0xb3642e1f
.long 0x34008000, 0x00003400, 0xb4008000, 0x0000b400, 0xb4008000, 0xae1fb364, 0x31a8b1a8, 0x33642e1f
.long 0x34008000, 0x31a831a8, 0x00003400, 0xb1a831a8, 0xb4008000, 0xb364ae1f, 0xb1a8b1a8, 0xae1fb364
.long 0x34008000, 0x34008000, 0x34008000, 0x34008000, 0x00003400, 0x2e1f3364, 0x31a831a8, 0x33642e1f
.long 0xb4008000, 0xb1a831a8, 0x00003400, 0x31a831a8, 0x0000b400, 0xb364ae1f, 0xb1a831a8, 0x2e1f3364
.long 0x34008000, 0x0000b400, 0xb4008000, 0x00003400, 0x00003400, 0x3364ae1f, 0xb1a8b1a8, 0xae1f3364
.long 0xb4008000, 0x31a831a8, 0x0000b400, 0xb1a831a8, 0x0000b400, 0xae1f3364, 0x31a8b1a8, 0xb3642e1f
.long 0x34008000, 0xb4008000, 0x34008000, 0xb4008000, 0x00003400, 0xae1fb364, 0x31a831a8, 0xb364ae1f
.long 0xb4008000, 0x31a8b1a8, 0x00003400, 0xb1a8b1a8, 0x0000b400, 0x33642e1f, 0xb1a831a8, 0xae1fb364
.long 0x34008000, 0x00003400, 0xb4008000, 0x0000b400, 0x00003400, 0xb3642e1f, 0xb1a8b1a8, 0x2e1fb364
.long 0xb4008000, 0xb1a8b1a8, 0x0000b400, 0x31a8b1a8, 0x0000b400, 0x2e1fb364, 0x31a8b1a8, 0x3364ae1f
.long 0x80003400, 0x80003400, 0x80003400, 0x80003400, 0x80003400, 0xae1f3364, 0xb1a831a8, 0xb3642e1f
.long 0x80003400, 0xb1a831a8, 0xb4000000, 0xb1a8b1a8, 0x80003400, 0xb3642e1f, 0xb1a8b1a8, 0x2e1fb364
.long 0x80003400, 0xb4000000, 0x8000b400, 0x34000000, 0x80003400, 0xb364ae1f, 0x31a8b1a8, 0x2e1f3364
.long 0x80003400, 0xb1a8b1a8, 0x34000000, 0xb1a831a8, 0x80003400, 0xae1fb364, 0x31a831a8, 0xb364ae1f
.long 0x80003400, 0x8000b400, 0x80003400, 0x8000b400, 0x80003400, 0x2e1fb364, 0xb1a831a8, 0x3364ae1f
.long 0x80003400, 0x31a8b1a8, 0xb4000000, 0x31a831a8, 0x80003400, 0x3364ae1f, 0xb1a8b1a8, 0xae1f3364
.long 0x80003400, 0x34000000, 0x8000b400, 0xb4000000, 0x80003400, 0x33642e1f, 0x31a8b1a8, 0xae1fb364
.long 0x80003400, 0x31a831a8, 0x34000000, 0x31a8b1a8, 0x80003400, 0x2e1f3364, 0x31a831a8, 0x33642e1f
.long 0x80003400, 0x80003400, 0x80003400, 0x80003400, 0xb4000000, 0xb364ae1f, 0xb1a8b1a8, 0xae1fb364
.long 0x8000b400, 0x31a8b1a8, 0x34000000, 0x31a831a8, 0x34000000, 0x2e1f3364, 0xb1a831a8, 0xb364ae1f
.long 0x80003400, 0xb4000000, 0x8000b400, 0x34000000, 0xb4000000, 0x2e1fb364, 0x31a831a8, 0xb3642e1f
.long 0x8000b400, 0x31a831a8, 0xb4000000, 0x31a8b1a8, 0x34000000, 0xb3642e1f, 0x31a8b1a8, 0xae1f3364
.long 0x80003400, 0x8000b400, 0x80003400, 0x8000b400, 0xb4000000, 0x33642e1f, 0xb1a8b1a8, 0x2e1f3364
.long 0x8000b400, 0xb1a831a8, 0x34000000, 0xb1a8b1a8, 0x34000000, 0xae1fb364, 0xb1a831a8, 0x33642e1f
.long 0x80003400, 0x34000000, 0x8000b400, 0xb4000000, 0xb4000000, 0xae1f3364, 0x31a831a8, 0x3364ae1f
.long 0x8000b400, 0xb1a8b1a8, 0xb4000000, 0xb1a831a8, 0x34000000, 0x3364ae1f, 0x31a8b1a8, 0x2e1fb364
.long 0x80003400, 0x80003400, 0x80003400, 0x80003400, 0x8000b400, 0x2e1fb364, 0x31a8b1a8, 0x3364ae1f
.long 0x80003400, 0xb1a831a8, 0xb4000000, 0xb1a8b1a8, 0x8000b400, 0x3364ae1f, 0x31a831a8, 0xae1f3364
.long 0x80003400, 0xb4000000, 0x8000b400, 0x34000000, 0x8000b400, 0x33642e1f, 0xb1a831a8, 0xae1fb364
.long 0x80003400, 0xb1a8b1a8, 0x34000000, 0xb1a831a8, 0x8000b400, 0x2e1f3364, 0xb1a8b1a8, 0x33642e1f
.long 0x80003400, 0x8000b400, 0x80003400, 0x8000b400, 0x8000b400, 0xae1f3364, 0x31a8b1a8, 0xb3642e1f
.long 0x80003400, 0x31a8b1a8, 0xb4000000, 0x31a831a8, 0x8000b400, 0xb3642e1f, 0x31a831a8, 0x2e1fb364
.long 0x80003400, 0x34000000, 0x8000b400, 0xb4000000, 0x8000b400, 0xb364ae1f, 0xb1a831a8, 0x2e1f3364
.long 0x80003400, 0x31a831a8, 0x34000000, 0x31a8b1a8, 0x8000b400, 0xae1fb364, 0xb1a8b1a8, 0xb364ae1f
.long 0x80003400, 0x80003400, 0x80003400, 0x80003400, 0x34000000, 0x33642e1f, 0x31a831a8, 0x2e1f3364
.long 0x8000b400, 0x31a8b1a8, 0x34000000, 0x31a831a8, 0xb4000000, 0xae1fb364, 0x31a8b1a8, 0x33642e1f
.long 0x80003400, 0xb4000000, 0x8000b400, 0x34000000, 0x34000000, 0xae1f3364, 0xb1a8b1a8, 0x3364ae1f
.long 0x8000b400, 0x31a831a8, 0xb4000000, 0x31a8b1a8, 0xb4000000, 0x3364ae1f, 0xb1a831a8, 0x2e1fb364
.long 0x80003400, 0x8000b400, 0x80003400, 0x8000b400, 0x34000000, 0xb364ae1f, 0x31a831a8, 0xae1fb364
.long 0x8000b400, 0xb1a831a8, 0x34000000, 0xb1a8b1a8, 0xb4000000, 0x2e1f3364, 0x31a8b1a8, 0xb364ae1f
.long 0x80003400, 0x34000000, 0x8000b400, 0xb4000000, 0x34000000, 0x2e1fb364, 0xb1a8b1a8, 0xb3642e1f
.long 0x8000b400, 0xb1a8b1a8, 0xb4000000, 0xb1a831a8, 0xb4000000, 0xb3642e1f, 0xb1a831a8, 0xae1f3364
.long 0x34000000, 0x34000000, 0x34000000, 0x34000000, 0x34000000, 0x33642e1f, 0x31a831a8, 0x2e1f3364
.long 0x34000000, 0x31a831a8, 0x00003400, 0xb1a831a8, 0x34000000, 0x2e1f3364, 0xb1a831a8, 0xb364ae1f
.long 0x34000000, 0x00003400, 0xb4000000, 0x0000b400, 0x34000000, 0xae1f3364, 0xb1a8b1a8, 0x3364ae1f
.long 0x34000000, 0xb1a831a8, 0x0000b400, 0x31a831a8, 0x34000000, 0xb3642e1f, 0x31a8b1a8, 0xae1f3364
.long 0x34000000, 0xb4000000, 0x34000000, 0xb4000000, 0x34000000, 0xb364ae1f, 0x31a831a8, 0xae1fb364
.long 0x34000000, 0xb1a8b1a8, 0x00003400, 0x31a8b1a8, 0x34000000, 0xae1fb364, 0xb1a831a8, 0x33642e1f
.long 0x34000000, 0x0000b400, 0xb4000000, 0x00003400, 0x34000000, 0x2e1fb364, 0xb1a8b1a8, 0xb3642e1f
.long 0x34000000, 0x31a8b1a8, 0x0000b400, 0xb1a8b1a8, 0x34000000, 0x3364ae1f, 0x31a8b1a8, 0x2e1fb364
.long 0x34000000, 0x34000000, 0x34000000, 0x34000000, 0x00003400, 0xae1f3364, 0xb1a831a8, 0xb3642e1f
.long 0xb4000000, 0xb1a8b1a8, 0x0000b400, 0x31a8b1a8, 0x0000b400, 0x3364ae1f, 0x31a831a8, 0xae1f3364
.long 0x34000000, 0x00003400, 0xb4000000, 0x0000b400, 0x00003400, 0xb364ae1f, 0x31a8b1a8, 0x2e1f3364
.long 0xb4000000, 0x31a8b1a8, 0x00003400, 0xb1a8b1a8, 0x0000b400, 0x2e1f3364, 0xb1a8b1a8, 0x33642e1f
.long 0x34000000, 0xb4000000, 0x34000000, 0xb4000000, 0x00003400, 0x2e1fb364, 0xb1a831a8, 0x3364ae1f
.long 0xb4000000, 0x31a831a8, 0x0000b400, 0xb1a831a8, 0x0000b400, 0xb3642e1f, 0x31a831a8, 0x2e1fb364
.long 0x34000000, 0x0000b400, 0xb4000000, 0x00003400, 0x00003400, 0x33642e1f, 0x31a8b1a8, 0xae1fb364
.long 0xb4000000, 0xb1a831a8, 0x00003400, 0x31a831a8, 0x0000b400, 0xae1fb364, 0xb1a8b1a8, 0xb364ae1f
.long 0x34000000, 0x34000000, 0x34000000, 0x34000000, 0xb4000000, 0xb364ae1f, 0xb1a8b1a8, 0xae1fb364
.long 0x34000000, 0x31a831a8, 0x00003400, 0xb1a831a8, 0xb4000000, 0xae1fb364, 0x31a8b1a8, 0x33642e1f
.long 0x34000000, 0x00003400, 0xb4000000, 0x0000b400, 0xb4000000, 0x2e1fb364, 0x31a831a8, 0xb3642e1f
.long 0x34000000, 0xb1a831a8, 0x0000b400, 0x31a831a8, 0xb4000000, 0x3364ae1f, 0xb1a831a8, 0x2e1fb364
.long 0x34000000, 0xb4000000, 0x34000000, 0xb4000000, 0xb4000000, 0x33642e1f, 0xb1a8b1a8, 0x2e1f3364
.long 0x34000000, 0xb1a8b1a8, 0x00003400, 0x31a8b1a8, 0xb4000000, 0x2e1f3364, 0x31a8b1a8, 0xb364ae1f
.long 0x34000000, 0x0000b400, 0xb4000000, 0x00003400, 0xb4000000, 0xae1f3364, 0x31a831a8, 0x3364ae1f
.long 0x34000000, 0x31a8b1a8, 0x0000b400, 0xb1a8b1a8, 0xb4000000, 0xb3642e1f, 0xb1a831a8, 0xae1f3364
.long 0x34000000, 0x34000000, 0x34000000, 0x34000000, 0x0000b400, 0x2e1fb364, 0x31a8b1a8, 0x3364ae1f
.long 0xb4000000, 0xb1a8b1a8, 0x0000b400, 0x31a8b1a8, 0x00003400, 0xb3642e1f, 0xb1a8b1a8, 0x2e1fb364
.long 0x34000000, 0x00003400, 0xb4000000, 0x0000b400, 0x0000b400, 0x33642e1f, 0xb1a831a8, 0xae1fb364
.long 0xb4000000, 0x31a8b1a8, 0x00003400, 0xb1a8b1a8, 0x00003400, 0xae1fb364, 0x31a831a8, 0xb364ae1f
.long 0x34000000, 0xb4000000, 0x34000000, 0xb4000000, 0x0000b400, 0xae1f3364, 0x31a8b1a8, 0xb3642e1f
.long 0xb4000000, 0x31a831a8, 0x0000b400, 0xb1a831a8, 0x00003400, 0x3364ae1f, 0xb1a8b1a8, 0xae1f3364
.long 0x34000000, 0x0000b400, 0xb4000000, 0x00003400, 0x0000b400, 0xb364ae1f, 0xb1a831a8, 0x2e1f3364
.long 0xb4000000, 0xb1a831a8, 0x00003400, 0x31a831a8, 0x00003400, 0x2e1f3364, 0x31a831a8, 0x33642e1f
.long 0x3f800000, 0x3f800000, 0x3f800000, 0x3f800000, 0x3f800000, 0x3f7fec43, 0x3f7fb10f, 0x3f7f4e6d
.long 0x3f800000, 0x3f7fb10f, 0x3f7ec46d, 0x3f7d3aac, 0x3f800000, 0x3f7f4e6d, 0x3f7d3aac, 0x3f79c79d
.long 0x3f800000, 0x3f7ec46d, 0x3f7b14be, 0x3f74fa0b, 0x3f800000, 0x3f7e1324, 0x3f7853f8, 0x3f6ed89e
.long 0x3f800000, 0x3f7d3aac, 0x3f74fa0b, 0x3f676bd8, 0x3f800000, 0x3f7c3b28, 0x3f710908, 0x3f5ebe05
.long 0x3f800000, 0x3f7b14be, 0x3f6c835e, 0x3f54db31, 0x3f800000, 0x3f79c79d, 0x3f676bd8, 0x3f49d112
.long 0x3f800000, 0x3f7853f8, 0x3f61c598, 0x3f3daef9, 0x3f800000, 0x3f76ba07, 0x3f5b941a, 0x3f3085bb
.long 0x3f800000, 0x3f74fa0b, 0x3f54db31, 0x3f226799, 0x3f800000, 0x3f731447, 0x3f4d9f02, 0x3f13682a
.long 0x3f800000, 0x3f710908, 0x3f45e403, 0x3f039c3d, 0x3f800000, 0x3f6ed89e, 0x3f3daef9, 0x3ee63375
.long 0x3f800000, 0x3f800000, 0x3f800000, 0x3f800000, 0x3f7ec46d, 0x3f7e1324, 0x3f7d3aac, 0x3f7c3b28
.long 0x3f7b14be, 0x3f7853f8, 0x3f74fa0b, 0x3f710908, 0x3f74fa0b, 0x3f6ed89e, 0x3f676bd8, 0x3f5ebe05
.long 0x3f6c835e, 0x3f61c598, 0x3f54db31, 0x3f45e403, 0x3f61c598, 0x3f514d3d, 0x3f3daef9, 0x3f273656
.long 0x3f54db31, 0x3f3daef9, 0x3f226799, 0x3f039c3d, 0x3f45e403, 0x3f273656, 0x3f039c3d, 0x3eb8442a
.long 0x3f3504f3, 0x3f0e39da, 0x3ec3ef15, 0x3e47c5c2, 0x3f226799, 0x3ee63375, 0x3e78cfcc, 0x3cc90ab0
.long 0x3f0e39da, 0x3eac7cd4, 0x3dc8bd36, 0xbe164083, 0x3ef15aea, 0x3e605c13, 0xbd48fb30, 0xbea09ae5
.long 0x3ec3ef15, 0x3dc8bd36, 0xbe47c5c2, 0xbef15aea, 0x3e94a031, 0xbcc90ab0, 0xbeac7cd4, 0xbf1d7fd1
.long 0x3e47c5c2, 0xbe164083, 0xbef15aea, 0xbf3daef9, 0x3dc8bd36, 0xbe888e93, 0xbf187fc0, 0xbf584853
.long 0x3f800000, 0x3f800000, 0x3f800000, 0x3f800000, 0x3f7b14be, 0x3f79c79d, 0x3f7853f8, 0x3f76ba07
.long 0x3f6c835e, 0x3f676bd8, 0x3f61c598, 0x3f5b941a, 0x3f54db31, 0x3f49d112, 0x3f3daef9, 0x3f3085bb
.long 0x3f3504f3, 0x3f226799, 0x3f0e39da, 0x3ef15aea, 0x3f0e39da, 0x3ee63375, 0x3eac7cd4, 0x3e605c13
.long 0x3ec3ef15, 0x3e78cfcc, 0x3dc8bd36, 0xbd48fb30, 0x3e47c5c2, 0x3cc90ab0, 0xbe164083, 0xbea09ae5
.long 0x00000000, 0xbe47c5c2, 0xbec3ef15, 0xbf0e39da, 0xbe47c5c2, 0xbecf7bca, 0xbf187fc0, 0xbf41d870
.long 0xbec3ef15, 0xbf187fc0, 0xbf45e403, 0xbf676bd8, 0xbf0e39da, 0xbf41d870, 0xbf676bd8, 0xbf7c3b28
.long 0xbf3504f3, 0xbf61c598, 0xbf7b14be, 0xbf7ec46d, 0xbf54db31, 0xbf76ba07, 0xbf7fb10f, 0xbf6ed89e
.long 0xbf6c835e, 0xbf7fb10f, 0xbf74fa0b, 0xbf4d9f02, 0xbf7b14be, 0xbf7c3b28, 0xbf5b941a, 0xbf1d7fd1
.long 0x3f800000, 0x3f800000, 0x3f800000, 0x3f800000, 0x3f74fa0b, 0x3f731447, 0x3f710908, 0x3f6ed89e
.long 0x3f54db31, 0x3f4d9f02, 0x3f45e403, 0x3f3daef9, 0x3f226799, 0x3f13682a, 0x3f039c3d, 0x3ee63375
.long 0x3ec3ef15, 0x3e94a031, 0x3e47c5c2, 0x3dc8bd36, 0x3dc8bd36, 0xbcc90ab0, 0xbe164083, 0xbe888e93
.long 0xbe47c5c2, 0xbeac7cd4, 0xbef15aea, 0xbf187fc0, 0xbef15aea, 0xbf1d7fd1, 0xbf3daef9, 0xbf584853
.long 0xbf3504f3, 0xbf54db31, 0xbf6c835e, 0xbf7b14be, 0xbf61c598, 0xbf76ba07, 0xbf7fb10f, 0xbf7c3b28
.long 0xbf7b14be, 0xbf7fb10f, 0xbf74fa0b, 0xbf5b941a, 0xbf7ec46d, 0xbf6ed89e, 0xbf4d9f02, 0xbf1d7fd1
.long 0xbf6c835e, 0xbf45e403, 0xbf0e39da, 0xbe94a031, 0xbf45e403, 0xbf08f59b, 0xbe78cfcc, 0x3d96a905
.long 0xbf0e39da, 0xbe78cfcc, 0x3dc8bd36, 0x3edae880, 0xbe94a031, 0x3d96a905, 0x3edae880, 0x3f396842
.long 0x00000000, 0x00000000, 0x00000000, 0x00000000, 0x00000000, 0xbcc90ab0, 0xbd48fb30, 0xbd96a905
.long 0x00000000, 0xbd48fb30, 0xbdc8bd36, 0xbe164083, 0x00000000, 0xbd96a905, 0xbe164083, 0xbe605c13
.long 0x00000000, 0xbdc8bd36, 0xbe47c5c2, 0xbe94a031, 0x00000000, 0xbdfab273, 0xbe78cfcc, 0xbeb8442a
.long 0x00000000, 0xbe164083, 0xbe94a031, 0xbedae880, 0x00000000, 0xbe2f10a2, 0xbeac7cd4, 0xbefc5d27
.long 0x00000000, 0xbe47c5c2, 0xbec3ef15, 0xbf0e39da, 0x00000000, 0xbe605c13, 0xbedae880, 0xbf1d7fd1
.long 0x00000000, 0xbe78cfcc, 0xbef15aea, 0xbf2beb4a, 0x00000000, 0xbe888e93, 0xbf039c3d, 0xbf396842
.long 0x00000000, 0xbe94a031, 0xbf0e39da, 0xbf45e403, 0x00000000, 0xbea09ae5, 0xbf187fc0, 0xbf514d3d
.long 0x00000000, 0xbeac7cd4, 0xbf226799, 0xbf5b941a, 0x00000000, 0xbeb8442a, 0xbf2beb4a, 0xbf64aa59
.long 0x00000000, 0x00000000, 0x00000000, 0x00000000, 0xbdc8bd36, 0xbdfab273, 0xbe164083, 0xbe2f10a2
.long 0xbe47c5c2, 0xbe78cfcc, 0xbe94a031, 0xbeac7cd4, 0xbe94a031, 0xbeb8442a, 0xbedae880, 0xbefc5d27
.long 0xbec3ef15, 0xbef15aea, 0xbf0e39da, 0xbf226799, 0xbef15aea, 0xbf13682a, 0xbf2beb4a, 0xbf41d870
.long 0xbf0e39da, 0xbf2beb4a, 0xbf45e403, 0xbf5b941a, 0xbf226799, 0xbf41d870, 0xbf5b941a, 0xbf6ed89e
.long 0xbf3504f3, 0xbf54db31, 0xbf6c835e, 0xbf7b14be, 0xbf45e403, 0xbf64aa59, 0xbf7853f8, 0xbf7fec43
.long 0xbf54db31, 0xbf710908, 0xbf7ec46d, 0xbf7d3aac, 0xbf61c598, 0xbf79c79d, 0xbf7fb10f, 0xbf731447
.long 0xbf6c835e, 0xbf7ec46d, 0xbf7b14be, 0xbf61c598, 0xbf74fa0b, 0xbf7fec43, 0xbf710908, 0xbf49d112
.long 0xbf7b14be, 0xbf7d3aac, 0xbf61c598, 0xbf2beb4a, 0xbf7ec46d, 0xbf76ba07, 0xbf4d9f02, 0xbf08f59b
.long 0x00000000, 0x00000000, 0x00000000, 0x00000000, 0xbe47c5c2, 0xbe605c13, 0xbe78cfcc, 0xbe888e93
.long 0xbec3ef15, 0xbedae880, 0xbef15aea, 0xbf039c3d, 0xbf0e39da, 0xbf1d7fd1, 0xbf2beb4a, 0xbf396842
.long 0xbf3504f3, 0xbf45e403, 0xbf54db31, 0xbf61c598, 0xbf54db31, 0xbf64aa59, 0xbf710908, 0xbf79c79d
.long 0xbf6c835e, 0xbf7853f8, 0xbf7ec46d, 0xbf7fb10f, 0xbf7b14be, 0xbf7fec43, 0xbf7d3aac, 0xbf731447
.long 0xbf800000, 0xbf7b14be, 0xbf6c835e, 0xbf54db31, 0xbf7b14be, 0xbf6a09a7, 0xbf4d9f02, 0xbf273656
.long 0xbf6c835e, 0xbf4d9f02, 0xbf226799, 0xbedae880, 0xbf54db31, 0xbf273656, 0xbedae880, 0xbe2f10a2
.long 0xbf3504f3, 0xbef15aea, 0xbe47c5c2, 0x3dc8bd36, 0xbf0e39da, 0xbe888e93, 0x3d48fb30, 0x3eb8442a
.long 0xbec3ef15, 0xbd48fb30, 0x3e94a031, 0x3f187fc0, 0xbe47c5c2, 0x3e2f10a2, 0x3f039c3d, 0x3f49d112
.long 0x00000000, 0x00000000, 0x00000000, 0x00000000, 0xbe94a031, 0xbea09ae5, 0xbeac7cd4, 0xbeb8442a
.long 0xbf0e39da, 0xbf187fc0, 0xbf226799, 0xbf2beb4a, 0xbf45e403, 0xbf514d3d, 0xbf5b941a, 0xbf64aa59
.long 0xbf6c835e, 0xbf74fa0b, 0xbf7b14be, 0xbf7ec46d, 0xbf7ec46d, 0xbf7fec43, 0xbf7d3aac, 0xbf76ba07
.long 0xbf7b14be, 0xbf710908, 0xbf61c598, 0xbf4d9f02, 0xbf61c598, 0xbf49d112, 0xbf2beb4a, 0xbf08f59b
.long 0xbf3504f3, 0xbf0e39da, 0xbec3ef15, 0xbe47c5c2, 0xbef15aea, 0xbe888e93, 0xbd48fb30, 0x3e2f10a2
.long 0xbe47c5c2, 0x3d48fb30, 0x3e94a031, 0x3f039c3d, 0x3dc8bd36, 0x3eb8442a, 0x3f187fc0, 0x3f49d112
.long 0x3ec3ef15, 0x3f226799, 0x3f54db31, 0x3f74fa0b, 0x3f226799, 0x3f584853, 0x3f7853f8, 0x3f7f4e6d
.long 0x3f54db31, 0x3f7853f8, 0x3f7ec46d, 0x3f676bd8, 0x3f74fa0b, 0x3f7f4e6d, 0x3f676bd8, 0x3f3085bb
.long 0x3f800000, 0x3f7b14be, 0x3f6c835e, 0x3f54db31, 0x3f7ffb11, 0x3f7a7302, 0x3f6b4b0c, 0x3f531849
.long 0x3f7fec43, 0x3f79c79d, 0x3f6a09a7, 0x3f514d3d, 0x3f7fd397, 0x3f791298, 0x3f68bf3c, 0x3f4f7a1f
.long 0x3f7fb10f, 0x3f7853f8, 0x3f676bd8, 0x3f4d9f02, 0x3f7f84ab, 0x3f778bc5, 0x3f660f88, 0x3f4bbbf8
.long 0x3f7f4e6d, 0x3f76ba07, 0x3f64aa59, 0x3f49d112, 0x3f7f0e58, 0x3f75dec6, 0x3f633c5a, 0x3f47de65
.long 0x3f7ec46d, 0x3f74fa0b, 0x3f61c598, 0x3f45e403, 0x3f7e70b0, 0x3f740bdd, 0x3f604621, 0x3f43e200
.long 0x3f7e1324, 0x3f731447, 0x3f5ebe05, 0x3f41d870, 0x3f7dabcc, 0x3f721352, 0x3f5d2d53, 0x3f3fc767
.long 0x3f7d3aac, 0x3f710908, 0x3f5b941a, 0x3f3daef9, 0x3f7cbfc9, 0x3f6ff573, 0x3f59f26a, 0x3f3b8f3b
.long 0x3f7c3b28, 0x3f6ed89e, 0x3f584853, 0x3f396842, 0x3f7baccd, 0x3f6db293, 0x3f5695e5, 0x3f373a23
.long 0x3f3504f3, 0x3f0e39da, 0x3ec3ef15, 0x3e47c5c2, 0x3f32c8c9, 0x3f0b9a6b, 0x3ebe1d4a, 0x3e3b6ecf
.long 0x3f3085bb, 0x3f08f59b, 0x3eb8442a, 0x3e2f10a2, 0x3f2e3bde, 0x3f064b82, 0x3eb263ef, 0x3e22abb6
.long 0x3f2beb4a, 0x3f039c3d, 0x3eac7cd4, 0x3e164083, 0x3f299415, 0x3f00e7e4, 0x3ea68f12, 0x3e09cf86
.long 0x3f273656, 0x3efc5d27, 0x3ea09ae5, 0x3dfab273, 0x3f24d225, 0x3ef6e0cb, 0x3e9aa086, 0x3de1bc2e
.long 0x3f226799, 0x3ef15aea, 0x3e94a031, 0x3dc8bd36, 0x3f1ff6cb, 0x3eebcbbb, 0x3e8e9a22, 0x3dafb680
.long 0x3f1d7fd1, 0x3ee63375, 0x3e888e93, 0x3d96a905, 0x3f1b02c6, 0x3ee0924f, 0x3e827dc0, 0x3d7b2b74
.long 0x3f187fc0, 0x3edae880, 0x3e78cfcc, 0x3d48fb30, 0x3f15f6d9, 0x3ed53641, 0x3e6c9a7f, 0x3d16c32c
.long 0x3f13682a, 0x3ecf7bca, 0x3e605c13, 0x3cc90ab0, 0x3f10d3cd, 0x3ec9b953, 0x3e541501, 0x3c490e90
.long 0x00000000, 0xbe47c5c2, 0xbec3ef15, 0xbf0e39da, 0xbc490e90, 0xbe541501, 0xbec9b953, 0xbf10d3cd
.long 0xbcc90ab0, 0xbe605c13, 0xbecf7bca, 0xbf13682a, 0xbd16c32c, 0xbe6c9a7f, 0xbed53641, 0xbf15f6d9
.long 0xbd48fb30, 0xbe78cfcc, 0xbedae880, 0xbf187fc0, 0xbd7b2b74, 0xbe827dc0, 0xbee0924f, 0xbf1b02c6
.long 0xbd96a905, 0xbe888e93, 0xbee63375, 0xbf1d7fd1, 0xbdafb680, 0xbe8e9a22, 0xbeebcbbb, 0xbf1ff6cb
.long 0xbdc8bd36, 0xbe94a031, 0xbef15aea, 0xbf226799, 0xbde1bc2e, 0xbe9aa086, 0xbef6e0cb, 0xbf24d225
.long 0xbdfab273, 0xbea09ae5, 0xbefc5d27, 0xbf273656, 0xbe09cf86, 0xbea68f12, 0xbf00e7e4, 0xbf299415
.long 0xbe164083, 0xbeac7cd4, 0xbf039c3d, 0xbf2beb4a, 0xbe22abb6, 0xbeb263ef, 0xbf064b82, 0xbf2e3bde
.long 0xbe2f10a2, 0xbeb8442a, 0xbf08f59b, 0xbf3085bb, 0xbe3b6ecf, 0xbebe1d4a, 0xbf0b9a6b, 0xbf32c8c9
.long 0xbf3504f3, 0xbf54db31, 0xbf6c835e, 0xbf7b14be, 0xbf373a23, 0xbf5695e5, 0xbf6db293, 0xbf7baccd
.long 0xbf396842, 0xbf584853, 0xbf6ed89e, 0xbf7c3b28, 0xbf3b8f3b, 0xbf59f26a, 0xbf6ff573, 0xbf7cbfc9
.long 0xbf3daef9, 0xbf5b941a, 0xbf710908, 0xbf7d3aac, 0xbf3fc767, 0xbf5d2d53, 0xbf721352, 0xbf7dabcc
.long 0xbf41d870, 0xbf5ebe05, 0xbf731447, 0xbf7e1324, 0xbf43e200, 0xbf604621, 0xbf740bdd, 0xbf7e70b0
.long 0xbf45e403, 0xbf61c598, 0xbf74fa0b, 0xbf7ec46d, 0xbf47de65, 0xbf633c5a, 0xbf75dec6, 0xbf7f0e58
.long 0xbf49d112, 0xbf64aa59, 0xbf76ba07, 0xbf7f4e6d, 0xbf4bbbf8, 0xbf660f88, 0xbf778bc5, 0xbf7f84ab
.long 0xbf4d9f02, 0xbf676bd8, 0xbf7853f8, 0xbf7fb10f, 0xbf4f7a1f, 0xbf68bf3c, 0xbf791298, 0xbf7fd397
.long 0xbf514d3d, 0xbf6a09a7, 0xbf79c79d, 0xbf7fec43, 0xbf531849, 0xbf6b4b0c, 0xbf7a7302, 0xbf7ffb11
.long 0x00000000, 0xbe47c5c2, 0xbec3ef15, 0xbf0e39da, 0xbc490e90, 0xbe541501, 0xbec9b953, 0xbf10d3cd
.long 0xbcc90ab0, 0xbe605c13, 0xbecf7bca, 0xbf13682a, 0xbd16c32c, 0xbe6c9a7f, 0xbed53641, 0xbf15f6d9
.long 0xbd48fb30, 0xbe78cfcc, 0xbedae880, 0xbf187fc0, 0xbd7b2b74, 0xbe827dc0, 0xbee0924f, 0xbf1b02c6
.long 0xbd96a905, 0xbe888e93, 0xbee63375, 0xbf1d7fd1, 0xbdafb680, 0xbe8e9a22, 0xbeebcbbb, 0xbf1ff6cb
.long 0xbdc8bd36, 0xbe94a031, 0xbef15aea, 0xbf226799, 0xbde1bc2e, 0xbe9aa086, 0xbef6e0cb, 0xbf24d225
.long 0xbdfab273, 0xbea09ae5, 0xbefc5d27, 0xbf273656, 0xbe09cf86, 0xbea68f12, 0xbf00e7e4, 0xbf299415
.long 0xbe164083, 0xbeac7cd4, 0xbf039c3d, 0xbf2beb4a, 0xbe22abb6, 0xbeb263ef, 0xbf064b82, 0xbf2e3bde
.long 0xbe2f10a2, 0xbeb8442a, 0xbf08f59b, 0xbf3085bb, 0xbe3b6ecf, 0xbebe1d4a, 0xbf0b9a6b, 0xbf32c8c9
.long 0xbf3504f3, 0xbf54db31, 0xbf6c835e, 0xbf7b14be, 0xbf373a23, 0xbf5695e5, 0xbf6db293, 0xbf7baccd
.long 0xbf396842, 0xbf584853, 0xbf6ed89e, 0xbf7c3b28, 0xbf3b8f3b, 0xbf59f26a, 0xbf6ff573, 0xbf7cbfc9
.long 0xbf3daef9, 0xbf5b941a, 0xbf710908, 0xbf7d3aac, 0xbf3fc767, 0xbf5d2d53, 0xbf721352, 0xbf7dabcc
.long 0xbf41d870, 0xbf5ebe05, 0xbf731447, 0xbf7e1324, 0xbf43e200, 0xbf604621, 0xbf740bdd, 0xbf7e70b0
.long 0xbf45e403, 0xbf61c598, 0xbf74fa0b, 0xbf7ec46d, 0xbf47de65, 0xbf633c5a, 0xbf75dec6, 0xbf7f0e58
.long 0xbf49d112, 0xbf64aa59, 0xbf76ba07, 0xbf7f4e6d, 0xbf4bbbf8, 0xbf660f88, 0xbf778bc5, 0xbf7f84ab
.long 0xbf4d9f02, 0xbf676bd8, 0xbf7853f8, 0xbf7fb10f, 0xbf4f7a1f, 0xbf68bf3c, 0xbf791298, 0xbf7fd397
.long 0xbf514d3d, 0xbf6a09a7, 0xbf79c79d, 0xbf7fec43, 0xbf531849, 0xbf6b4b0c, 0xbf7a7302, 0xbf7ffb11
.long 0xbf800000, 0xbf7b14be, 0xbf6c835e, 0xbf54db31, 0xbf7ffb11, 0xbf7a7302, 0xbf6b4b0c, 0xbf531849
.long 0xbf7fec43, 0xbf79c79d, 0xbf6a09a7, 0xbf514d3d, 0xbf7fd397, 0xbf791298, 0xbf68bf3c, 0xbf4f7a1f
.long 0xbf7fb10f, 0xbf7853f8, 0xbf676bd8, 0xbf4d9f02, 0xbf7f84ab, 0xbf778bc5, 0xbf660f88, 0xbf4bbbf8
.long 0xbf7f4e6d, 0xbf76ba07, 0xbf64aa59, 0xbf49d112, 0xbf7f0e58, 0xbf75dec6, 0xbf633c5a, 0xbf47de65
.long 0xbf7ec46d, 0xbf74fa0b, 0xbf61c598, 0xbf45e403, 0xbf7e70b0, 0xbf740bdd, 0xbf604621, 0xbf43e200
.long 0xbf7e1324, 0xbf731447, 0xbf5ebe05, 0xbf41d870, 0xbf7dabcc, 0xbf721352, 0xbf5d2d53, 0xbf3fc767
.long 0xbf7d3aac, 0xbf710908, 0xbf5b941a, 0xbf3daef9, 0xbf7cbfc9, 0xbf6ff573, 0xbf59f26a, 0xbf3b8f3b
.long 0xbf7c3b28, 0xbf6ed89e, 0xbf584853, 0xbf396842, 0xbf7baccd, 0xbf6db293, 0xbf5695e5, 0xbf373a23
.long 0xbf3504f3, 0xbf0e39da, 0xbec3ef15, 0xbe47c5c2, 0xbf32c8c9, 0xbf0b9a6b, 0xbebe1d4a, 0xbe3b6ecf
.long 0xbf3085bb, 0xbf08f59b, 0xbeb8442a, 0xbe2f10a2, 0xbf2e3bde, 0xbf064b82, 0xbeb263ef, 0xbe22abb6
.long 0xbf2beb4a, 0xbf039c3d, 0xbeac7cd4, 0xbe164083, 0xbf299415, 0xbf00e7e4, 0xbea68f12, 0xbe09cf86
.long 0xbf273656, 0xbefc5d27, 0xbea09ae5, 0xbdfab273, 0xbf24d225, 0xbef6e0cb, 0xbe9aa086, 0xbde1bc2e
.long 0xbf226799, 0xbef15aea, 0xbe94a031, 0xbdc8bd36, 0xbf1ff6cb, 0xbeebcbbb, 0xbe8e9a22, 0xbdafb680
.long 0xbf1d7fd1, 0xbee63375, 0xbe888e93, 0xbd96a905, 0xbf1b02c6, 0xbee0924f, 0xbe827dc0, 0xbd7b2b74
.long 0xbf187fc0, 0xbedae880, 0xbe78cfcc, 0xbd48fb30, 0xbf15f6d9, 0xbed53641, 0xbe6c9a7f, 0xbd16c32c
.long 0xbf13682a, 0xbecf7bca, 0xbe605c13, 0xbcc90ab0, 0xbf10d3cd, 0xbec9b953, 0xbe541501, 0xbc490e90
.long 0x3f800000, 0x3f800000, 0x3f800000, 0x3f800000, 0x3f800000, 0x3f7ec46d, 0x3f7b14be, 0x3f74fa0b
.long 0x3f800000, 0x3f7b14be, 0x3f6c835e, 0x3f54db31, 0x3f800000, 0x3f74fa0b, 0x3f54db31, 0x3f226799
.long 0x3f800000, 0x3f6c835e, 0x3f3504f3, 0x3ec3ef15, 0x3f800000, 0x3f61c598, 0x3f0e39da, 0x3dc8bd36
.long 0x3f800000, 0x3f54db31, 0x3ec3ef15, 0xbe47c5c2, 0x3f800000, 0x3f45e403, 0x3e47c5c2, 0xbef15aea
.long 0x3f800000, 0x3f3504f3, 0x00000000, 0xbf3504f3, 0x3f800000, 0x3f226799, 0xbe47c5c2, 0xbf61c598
.long 0x3f800000, 0x3f0e39da, 0xbec3ef15, 0xbf7b14be, 0x3f800000, 0x3ef15aea, 0xbf0e39da, 0xbf7ec46d
.long 0x3f800000, 0x3ec3ef15, 0xbf3504f3, 0xbf6c835e, 0x3f800000, 0x3e94a031, 0xbf54db31, 0xbf45e403
.long 0x3f800000, 0x3e47c5c2, 0xbf6c835e, 0xbf0e39da, 0x3f800000, 0x3dc8bd36, 0xbf7b14be, 0xbe94a031
.long 0x3f800000, 0x3f800000, 0x3f800000, 0x3f800000, 0x3f800000, 0x3f7ec46d, 0x3f7b14be, 0x3f74fa0b
.long 0x3f800000, 0x3f7b14be, 0x3f6c835e, 0x3f54db31, 0x3f800000, 0x3f74fa0b, 0x3f54db31, 0x3f226799
.long 0x3f800000, 0x3f6c835e, 0x3f3504f3, 0x3ec3ef15, 0x3f800000, 0x3f61c598, 0x3f0e39da, 0x3dc8bd36
.long 0x3f800000, 0x3f54db31, 0x3ec3ef15, 0xbe47c5c2, 0x3f800000, 0x3f45e403, 0x3e47c5c2, 0xbef15aea
.long 0x3f800000, 0x3f3504f3, 0x00000000, 0xbf3504f3, 0x3f800000, 0x3f226799, 0xbe47c5c2, 0xbf61c598
.long 0x3f800000, 0x3f0e39da, 0xbec3ef15, 0xbf7b14be, 0x3f800000, 0x3ef15aea, 0xbf0e39da, 0xbf7ec46d
.long 0x3f800000, 0x3ec3ef15, 0xbf3504f3, 0xbf6c835e, 0x3f800000, 0x3e94a031, 0xbf54db31, 0xbf45e403
.long 0x3f800000, 0x3e47c5c2, 0xbf6c835e, 0xbf0e39da, 0x3f800000, 0x3dc8bd36, 0xbf7b14be, 0xbe94a031
.long 0x3f800000, 0x3f800000, 0x3f800000, 0x3f800000, 0x3f800000, 0x3f7ec46d, 0x3f7b14be, 0x3f74fa0b
.long 0x3f800000, 0x3f7b14be, 0x3f6c835e, 0x3f54db31, 0x3f800000, 0x3f74fa0b, 0x3f54db31, 0x3f226799
.long 0x3f800000, 0x3f6c835e, 0x3f3504f3, 0x3ec3ef15, 0x3f800000, 0x3f61c598, 0x3f0e39da, 0x3dc8bd36
.long 0x3f800000, 0x3f54db31, 0x3ec3ef15, 0xbe47c5c2, 0x3f800000, 0x3f45e403, 0x3e47c5c2, 0xbef15aea
.long 0x3f800000, 0x3f3504f3, 0x00000000, 0xbf3504f3, 0x3f800000, 0x3f226799, 0xbe47c5c2, 0xbf61c598
.long 0x3f800000, 0x3f0e39da, 0xbec3ef15, 0xbf7b14be, 0x3f800000, 0x3ef15aea, 0xbf0e39da, 0xbf7ec46d
.long 0x3f800000, 0x3ec3ef15, 0xbf3504f3, 0xbf6c835e, 0x3f800000, 0x3e94a031, 0xbf54db31, 0xbf45e403
.long 0x3f800000, 0x3e47c5c2, 0xbf6c835e, 0xbf0e39da, 0x3f800000, 0x3dc8bd36, 0xbf7b14be, 0xbe94a031
.long 0x3f800000, 0x3f800000, 0x3f800000, 0x3f800000, 0x3f800000, 0x3f7ec46d, 0x3f7b14be, 0x3f74fa0b
.long 0x3f800000, 0x3f7b14be, 0x3f6c835e, 0x3f54db31, 0x3f800000, 0x3f74fa0b, 0x3f54db31, 0x3f226799
.long 0x3f800000, 0x3f6c835e, 0x3f3504f3, 0x3ec3ef15, 0x3f800000, 0x3f61c598, 0x3f0e39da, 0x3dc8bd36
.long 0x3f800000, 0x3f54db31, 0x3ec3ef15, 0xbe47c5c2, 0x3f800000, 0x3f45e403, 0x3e47c5c2, 0xbef15aea
.long 0x3f800000, 0x3f3504f3, 0x00000000, 0xbf3504f3, 0x3f800000, 0x3f226799, 0xbe47c5c2, 0xbf61c598
.long 0x3f800000, 0x3f0e39da, 0xbec3ef15, 0xbf7b14be, 0x3f800000, 0x3ef15aea, 0xbf0e39da, 0xbf7ec46d
.long 0x3f800000, 0x3ec3ef15, 0xbf3504f3, 0xbf6c835e, 0x3f800000, 0x3e94a031, 0xbf54db31, 0xbf45e403
.long 0x3f800000, 0x3e47c5c2, 0xbf6c835e, 0xbf0e39da, 0x3f800000, 0x3dc8bd36, 0xbf7b14be, 0xbe94a031
.long 0x00000000, 0x00000000, 0x00000000, 0x00000000, 0x00000000, 0x3dc8bd36, 0x3e47c5c2, 0x3e94a031
.long 0x00000000, 0x3e47c5c2, 0x3ec3ef15, 0x3f0e39da, 0x00000000, 0x3e94a031, 0x3f0e39da, 0x3f45e403
.long 0x00000000, 0x3ec3ef15, 0x3f3504f3, 0x3f6c835e, 0x00000000, 0x3ef15aea, 0x3f54db31, 0x3f7ec46d
.long 0x00000000, 0x3f0e39da, 0x3f6c835e, 0x3f7b14be, 0x00000000, 0x3f226799, 0x3f7b14be, 0x3f61c598
.long 0x00000000, 0x3f3504f3, 0x3f800000, 0x3f3504f3, 0x00000000, 0x3f45e403, 0x3f7b14be, 0x3ef15aea
.long 0x00000000, 0x3f54db31, 0x3f6c835e, 0x3e47c5c2, 0x00000000, 0x3f61c598, 0x3f54db31, 0xbdc8bd36
.long 0x00000000, 0x3f6c835e, 0x3f3504f3, 0xbec3ef15, 0x00000000, 0x3f74fa0b, 0x3f0e39da, 0xbf226799
.long 0x00000000, 0x3f7b14be, 0x3ec3ef15, 0xbf54db31, 0x00000000, 0x3f7ec46d, 0x3e47c5c2, 0xbf74fa0b
.long 0x00000000, 0x00000000, 0x00000000, 0x00000000, 0x00000000, 0x3dc8bd36, 0x3e47c5c2, 0x3e94a031
.long 0x00000000, 0x3e47c5c2, 0x3ec3ef15, 0x3f0e39da, 0x00000000, 0x3e94a031, 0x3f0e39da, 0x3f45e403
.long 0x00000000, 0x3ec3ef15, 0x3f3504f3, 0x3f6c835e, 0x00000000, 0x3ef15aea, 0x3f54db31, 0x3f7ec46d
.long 0x00000000, 0x3f0e39da, 0x3f6c835e, 0x3f7b14be, 0x00000000, 0x3f226799, 0x3f7b14be, 0x3f61c598
.long 0x00000000, 0x3f3504f3, 0x3f800000, 0x3f3504f3, 0x00000000, 0x3f45e403, 0x3f7b14be, 0x3ef15aea
.long 0x00000000, 0x3f54db31, 0x3f6c835e, 0x3e47c5c2, 0x00000000, 0x3f61c598, 0x3f54db31, 0xbdc8bd36
.long 0x00000000, 0x3f6c835e, 0x3f3504f3, 0xbec3ef15, 0x00000000, 0x3f74fa0b, 0x3f0e39da, 0xbf226799
.long 0x00000000, 0x3f7b14be, 0x3ec3ef15, 0xbf54db31, 0x00000000, 0x3f7ec46d, 0x3e47c5c2, 0xbf74fa0b
.long 0x00000000, 0x00000000, 0x00000000, 0x00000000, 0x00000000, 0x3dc8bd36, 0x3e47c5c2, 0x3e94a031
.long 0x00000000, 0x3e47c5c2, 0x3ec3ef15, 0x3f0e39da, 0x00000000, 0x3e94a031, 0x3f0e39da, 0x3f45e403
.long 0x00000000, 0x3ec3ef15, 0x3f3504f3, 0x3f6c835e, 0x00000000, 0x3ef15aea, 0x3f54db31, 0x3f7ec46d
.long 0x00000000, 0x3f0e39da, 0x3f6c835e, 0x3f7b14be, 0x00000000, 0x3f226799, 0x3f7b14be, 0x3f61c598
.long 0x00000000, 0x3f3504f3, 0x3f800000, 0x3f3504f3, 0x00000000, 0x3f45e403, 0x3f7b14be, 0x3ef15aea
.long 0x00000000, 0x3f54db31, 0x3f6c835e, 0x3e47c5c2, 0x00000000, 0x3f61c598, 0x3f54db31, 0xbdc8bd36
.long 0x00000000, 0x3f6c835e, 0x3f3504f3, 0xbec3ef15, 0x00000000, 0x3f74fa0b, 0x3f0e39da, 0xbf226799
.long 0x00000000, 0x3f7b14be, 0x3ec3ef15, 0xbf54db31, 0x00000000, 0x3f7ec46d, 0x3e47c5c2, 0xbf74fa0b
.long 0x00000000, 0x00000000, 0x00000000, 0x00000000, 0x00000000, 0x3dc8bd36, 0x3e47c5c2, 0x3e94a031
.long 0x00000000, 0x3e47c5c2, 0x3ec3ef15, 0x3f0e39da, 0x00000000, 0x3e94a031, 0x3f0e39da, 0x3f45e403
.long 0x00000000, 0x3ec3ef15, 0x3f3504f3, 0x3f6c835e, 0x00000000, 0x3ef15aea, 0x3f54db31, 0x3f7ec46d
.long 0x00000000, 0x3f0e39da, 0x3f6c835e, 0x3f7b14be, 0x00000000, 0x3f226799, 0x3f7b14be, 0x3f61c598
.long 0x00000000, 0x3f3504f3, 0x3f800000, 0x3f3504f3, 0x00000000, 0x3f45e403, 0x3f7b14be, 0x3ef15aea
.long 0x00000000, 0x3f54db31, 0x3f6c835e, 0x3e47c5c2, 0x00000000, 0x3f61c598, 0x3f54db31, 0xbdc8bd36
.long 0x00000000, 0x3f6c835e, 0x3f3504f3, 0xbec3ef15, 0x00000000, 0x3f74fa0b, 0x3f0e39da, 0xbf226799
.long 0x00000000, 0x3f7b14be, 0x3ec3ef15, 0xbf54db31, 0x00000000, 0x3f7ec46d, 0x3e47c5c2, 0xbf74fa0b
.long 0x31a831a8, 0x31a831a8, 0x31a831a8, 0x31a831a8, 0xb1a831a8, 0xb1a831a8, 0xb1a831a8, 0xb1a831a8
.long 0x31a831a8, 0x31a831a8, 0x31a831a8, 0x31a831a8, 0xb1a831a8, 0xb1a831a8, 0xb1a831a8, 0xb1a831a8
.long 0x31a831a8, 0xb1a831a8, 0xb1a8b1a8, 0x31a8b1a8, 0xb1a831a8, 0xb1a8b1a8, 0x31a8b1a8, 0x31a831a8
.long 0x31a831a8, 0xb1a831a8, 0xb1a8b1a8, 0x31a8b1a8, 0xb1a831a8, 0xb1a8b1a8, 0x31a8b1a8, 0x31a831a8
.long 0x31a831a8, 0xb1a8b1a8, 0x31a831a8, 0xb1a8b1a8, 0xb1a831a8, 0x31a8b1a8, 0xb1a831a8, 0x31a8b1a8
.long 0x31a831a8, 0xb1a8b1a8, 0x31a831a8, 0xb1a8b1a8, 0xb1a831a8, 0x31a8b1a8, 0xb1a831a8, 0x31a8b1a8
.long 0x31a831a8, 0x31a8b1a8, 0xb1a8b1a8, 0xb1a831a8, 0xb1a831a8, 0x31a831a8, 0x31a8b1a8, 0xb1a8b1a8
.long 0x31a831a8, 0x31a8b1a8, 0xb1a8b1a8, 0xb1a831a8, 0xb1a831a8, 0x31a831a8, 0x31a8b1a8, 0xb1a8b1a8
.long 0x800035a8, 0x800035a8, 0x800035a8, 0x800035a8, 0xb4003400, 0xb4003400, 0xb4003400, 0xb4003400
.long 0xb5a80000, 0xb5a80000, 0xb5a80000, 0xb5a80000, 0xb400b400, 0xb400b400, 0xb400b400, 0xb400b400
.long 0x800035a8, 0xb5a80000, 0x8000b5a8, 0x35a80000, 0xb4003400, 0xb400b400, 0x3400b400, 0x34003400
.long 0xb5a80000, 0x8000b5a8, 0x35a80000, 0x800035a8, 0xb400b400, 0x3400b400, 0x34003400, 0xb4003400
.long 0x800035a8, 0x8000b5a8, 0x800035a8, 0x8000b5a8, 0xb4003400, 0x3400b400, 0xb4003400, 0x3400b400
.long 0xb5a80000, 0x35a80000, 0xb5a80000, 0x35a80000, 0xb400b400, 0x34003400, 0xb400b400, 0x34003400
.long 0x800035a8, 0x35a80000, 0x8000b5a8, 0xb5a80000, 0xb4003400, 0x34003400, 0x3400b400, 0xb400b400
.long 0xb5a80000, 0x800035a8, 0x35a80000, 0x8000b5a8, 0xb400b400, 0xb4003400, 0x34003400, 0x3400b400
.long 0x800035a8, 0x800035a8, 0x800035a8, 0x800035a8, 0xb5a80000, 0xb5a80000, 0xb5a80000, 0xb5a80000
.long 0x8000b5a8, 0x8000b5a8, 0x8000b5a8, 0x8000b5a8, 0x35a80000, 0x35a80000, 0x35a80000, 0x35a80000
.long 0x800035a8, 0xb5a80000, 0x8000b5a8, 0x35a80000, 0xb5a80000, 0x8000b5a8, 0x35a80000, 0x800035a8
.long 0x8000b5a8, 0x35a80000, 0x800035a8, 0xb5a80000, 0x35a80000, 0x800035a8, 0xb5a80000, 0x8000b5a8
.long 0x800035a8, 0x8000b5a8, 0x800035a8, 0x8000b5a8, 0xb5a80000, 0x35a80000, 0xb5a80000, 0x35a80000
.long 0x8000b5a8, 0x800035a8, 0x8000b5a8, 0x800035a8, 0x35a80000, 0xb5a80000, 0x35a80000, 0xb5a80000
.long 0x800035a8, 0x35a80000, 0x8000b5a8, 0xb5a80000, 0xb5a80000, 0x800035a8, 0x35a80000, 0x8000b5a8
.long 0x8000b5a8, 0xb5a80000, 0x800035a8, 0x35a80000, 0x35a80000, 0x8000b5a8, 0xb5a80000, 0x800035a8
.long 0x800035a8, 0x800035a8, 0x800035a8, 0x800035a8, 0xb400b400, 0xb400b400, 0xb400b400, 0xb400b400
.long 0x35a80000, 0x35a80000, 0x35a80000, 0x35a80000, 0xb4003400, 0xb4003400, 0xb4003400, 0xb4003400
.long 0x800035a8, 0xb5a80000, 0x8000b5a8, 0x35a80000, 0xb400b400, 0x3400b400, 0x34003400, 0xb4003400
.long 0x35a80000, 0x800035a8, 0xb5a80000, 0x8000b5a8, 0xb4003400, 0xb400b400, 0x3400b400, 0x34003400
.long 0x800035a8, 0x8000b5a8, 0x800035a8, 0x8000b5a8, 0xb400b400, 0x34003400, 0xb400b400, 0x34003400
.long 0x35a80000, 0xb5a80000, 0x35a80000, 0xb5a80000, 0xb4003400, 0x3400b400, 0xb4003400, 0x3400b400
.long 0x800035a8, 0x35a80000, 0x8000b5a8, 0xb5a80000, 0xb400b400, 0xb4003400, 0x34003400, 0x3400b400
.long 0x35a80000, 0x8000b5a8, 0xb5a80000, 0x800035a8, 0xb4003400, 0x34003400, 0x3400b400, 0xb400b400
.long 0x31a831a8, 0x31a831a8, 0x31a831a8, 0x31a831a8, 0xb1a831a8, 0xb1a831a8, 0xb1a831a8, 0xb1a831a8
.long 0x31a831a8, 0x31a831a8, 0x31a831a8, 0x31a831a8, 0xb1a831a8, 0xb1a831a8, 0xb1a831a8, 0xb1a831a8
.long 0x31a831a8, 0xb1a831a8, 0xb1a8b1a8, 0x31a8b1a8, 0xb1a831a8, 0xb1a8b1a8, 0x31a8b1a8, 0x31a831a8
.long 0x31a831a8, 0xb1a831a8, 0xb1a8b1a8, 0x31a8b1a8, 0xb1a831a8, 0xb1a8b1a8, 0x31a8b1a8, 0x31a831a8
.long 0x31a831a8, 0xb1a8b1a8, 0x31a831a8, 0xb1a8b1a8, 0xb1a831a8, 0x31a8b1a8, 0xb1a831a8, 0x31a8b1a8
.long 0x31a831a8, 0xb1a8b1a8, 0x31a831a8, 0xb1a8b1a8, 0xb1a831a8, 0x31a8b1a8, 0xb1a831a8, 0x31a8b1a8
.long 0x31a831a8, 0x31a8b1a8, 0xb1a8b1a8, 0xb1a831a8, 0xb1a831a8, 0x31a831a8, 0x31a8b1a8, 0xb1a8b1a8
.long 0x31a831a8, 0x31a8b1a8, 0xb1a8b1a8, 0xb1a831a8, 0xb1a831a8, 0x31a831a8, 0x31a8b1a8, 0xb1a8b1a8
.long 0x8000b5a8, 0x8000b5a8, 0x8000b5a8, 0x8000b5a8, 0x3400b400, 0x3400b400, 0x3400b400, 0x3400b400
.long 0x35a80000, 0x35a80000, 0x35a80000, 0x35a80000, 0x34003400, 0x34003400, 0x34003400, 0x34003400
.long 0x8000b5a8, 0x35a80000, 0x800035a8, 0xb5a80000, 0x3400b400, 0x34003400, 0xb4003400, 0xb400b400
.long 0x35a80000, 0x800035a8, 0xb5a80000, 0x8000b5a8, 0x34003400, 0xb4003400, 0xb400b400, 0x3400b400
.long 0x8000b5a8, 0x800035a8, 0x8000b5a8, 0x800035a8, 0x3400b400, 0xb4003400, 0x3400b400, 0xb4003400
.long 0x35a80000, 0xb5a80000, 0x35a80000, 0xb5a80000, 0x34003400, 0xb400b400, 0x34003400, 0xb400b400
.long 0x8000b5a8, 0xb5a80000, 0x800035a8, 0x35a80000, 0x3400b400, 0xb400b400, 0xb4003400, 0x34003400
.long 0x35a80000, 0x8000b5a8, 0xb5a80000, 0x800035a8, 0x34003400, 0x3400b400, 0xb400b400, 0xb4003400
.long 0x800035a8, 0x800035a8, 0x800035a8, 0x800035a8, 0xb5a80000, 0xb5a80000, 0xb5a80000, 0xb5a80000
.long 0x8000b5a8, 0x8000b5a8, 0x8000b5a8, 0x8000b5a8, 0x35a80000, 0x35a80000, 0x35a80000, 0x35a80000
.long 0x800035a8, 0xb5a80000, 0x8000b5a8, 0x35a80000, 0xb5a80000, 0x8000b5a8, 0x35a80000, 0x800035a8
.long 0x8000b5a8, 0x35a80000, 0x800035a8, 0xb5a80000, 0x35a80000, 0x800035a8, 0xb5a80000, 0x8000b5a8
.long 0x800035a8, 0x8000b5a8, 0x800035a8, 0x8000b5a8, 0xb5a80000, 0x35a80000, 0xb5a80000, 0x35a80000
.long 0x8000b5a8, 0x800035a8, 0x8000b5a8, 0x800035a8, 0x35a80000, 0xb5a80000, 0x35a80000, 0xb5a80000
.long 0x800035a8, 0x35a80000, 0x8000b5a8, 0xb5a80000, 0xb5a80000, 0x800035a8, 0x35a80000, 0x8000b5a8
.long 0x8000b5a8, 0xb5a80000, 0x800035a8, 0x35a80000, 0x35a80000, 0x8000b5a8, 0xb5a80000, 0x800035a8
.long 0x8000b5a8, 0x8000b5a8, 0x8000b5a8, 0x8000b5a8, 0x34003400, 0x34003400, 0x34003400, 0x34003400
.long 0xb5a80000, 0xb5a80000, 0xb5a80000, 0xb5a80000, 0x3400b400, 0x3400b400, 0x3400b400, 0x3400b400
.long 0x8000b5a8, 0x35a80000, 0x800035a8, 0xb5a80000, 0x34003400, 0xb4003400, 0xb400b400, 0x3400b400
.long 0xb5a80000, 0x8000b5a8, 0x35a80000, 0x800035a8, 0x3400b400, 0x34003400, 0xb4003400, 0xb400b400
.long 0x8000b5a8, 0x800035a8, 0x8000b5a8, 0x800035a8, 0x34003400, 0xb400b400, 0x34003400, 0xb400b400
.long 0xb5a80000, 0x35a80000, 0xb5a80000, 0x35a80000, 0x3400b400, 0xb4003400, 0x3400b400, 0xb4003400
.long 0x8000b5a8, 0xb5a80000, 0x800035a8, 0x35a80000, 0x34003400, 0x3400b400, 0xb400b400, 0xb4003400
.long 0xb5a80000, 0x800035a8, 0x35a80000, 0x8000b5a8, 0x3400b400, 0xb400b400, 0xb4003400, 0x34003400
.size tbl, 20480
.section .rodata,"a"
.p2align 6
.amdhsa_kernel km_kernel
  .amdhsa_next_free_vgpr 128
  .amdhsa_next_free_sgpr 100
  .amdhsa_accum_offset 128
  .amdhsa_group_segment_fixed_size 0
  .amdhsa_kernarg_size 104
  .amdhsa_user_sgpr_count 2
  .amdhsa_user_sgpr_kernarg_segment_ptr 1
  .amdhsa_system_sgpr_workgroup_id_x 1
  .amdhsa_float_denorm_mode_32 3
  .amdhsa_float_denorm_mode_16_64 3
.end_amdhsa_kernel
```
